```python
import torch

def _softmax(x, axis=-1):
    return torch.softmax(x, dim=axis)
def _gelu(x):
    return torch.nn.functional.gelu(x, approximate="tanh")
def _silu(x):
    return torch.nn.functional.silu(x)
def _sigmoid(x):
    return torch.sigmoid(x)
def _layernorm(x, axis=-1, eps=1e-5):
    m = x.mean(dim=axis, keepdim=True)
    v = x.var(dim=axis, keepdim=True, unbiased=False)
    return (x - m) / torch.sqrt(v + eps)
def _scatter_add(tgt, idx, src, axis=0):
    return tgt.clone().index_add_(axis, idx, src)
def _segment_sum(src, seg, n):
    out = torch.zeros((n,) + src.shape[1:], dtype=src.dtype)
    return out.index_add_(0, seg, src)
def _pad(x, pw):
    flat = tuple(v for pair in reversed(pw) for v in pair)
    return torch.nn.functional.pad(x, flat)

kernel_name = 'standalone__fused_io_aware_attn__prompt'

def setup_inputs():

    _w = (lambda a: (lambda t: t.to(torch.bfloat16) if t.is_floating_point() else t)(torch.as_tensor(a)))
    B, H, S = 2, 32, 2048
    Dh = max(1, 1024 // 32)
    return {
        "q": _w((lambda *s: torch.randn(*s, dtype=torch.bfloat16) * 0.8)(B, H, S, Dh)),
        "k": _w((lambda *s: torch.randn(*s, dtype=torch.bfloat16) * 0.8)(B, H, S, Dh)),
        "v": _w((lambda *s: torch.randn(*s, dtype=torch.bfloat16) * 0.05)(B, H, S, Dh)),
    }

def reference(q, k, v):
    scale = q.shape[-1] ** -0.5
    s = torch.einsum('bhqd,bhkd->bhqk', q, k) * scale
    p = _softmax(s, axis=-1)
    return torch.einsum('bhqk,bhkd->bhqd', p, v)
```

```asm
; @launch grid=(256,1,1) block=(320,1,1) lds=131072
.amdgcn_target "amdgcn-amd-amdhsa--gfx950"
.text
.globl standalone__fused_io_aware_attn__prompt_kernel
.p2align 8
.type standalone__fused_io_aware_attn__prompt_kernel,@function
standalone__fused_io_aware_attn__prompt_kernel:
  s_load_dwordx8 s[4:11], s[0:1], 0
  s_cmp_ge_u32 s2, 256
  s_cbranch_scc1 L_end
  s_getpc_b64 s[40:41]
L_pc:
  v_lshlrev_b32 v1, 6, v0
  v_min_u32 v1, L_end-L_pc-12, v1
  global_load_dword v156, v1, s[40:41]
  v_lshrrev_b32 v1, 6, v0
  v_and_b32 v2, 63, v0
  s_and_b32 s3, s2, 7
  s_lshr_b32 s35, s2, 3
  v_readfirstlane_b32 s29, v1
  s_lshl_b32 s3, s3, 3
  s_lshr_b32 s36, s35, 2
  s_add_u32 s3, s3, s36
  s_lshl_b32 s28, s3, 17
  s_and_b32 s35, s35, 3
  s_lshl_b32 s35, s35, 15
  s_add_u32 s35, s28, s35
  s_lshl_b32 s36, s29, 13
  s_add_u32 s30, s35, s36
  s_add_u32 s37, s30, 4096
  s_lshl_b32 s32, s29, 11
  s_add_u32 s31, s28, s32
  v_and_b32 v3, 31, v2
  v_lshrrev_b32 v4, 5, v2
  v_lshlrev_b32 v5, 6, v3
  v_lshl_add_u32 v10, v4, 4, v5
  v_lshrrev_b32 v6, 4, v2
  v_and_b32 v7, 3, v2
  v_xor_b32 v6, v6, v7
  v_lshrrev_b32 v7, 2, v2
  v_lshlrev_b32 v7, 6, v7
  v_lshl_add_u32 v11, v6, 4, v7
  v_lshlrev_b32 v12, 4, v2
  s_mov_b32 s14, 8388608
  s_mov_b32 s15, 0x00020000
  s_mov_b32 s18, 8388608
  s_mov_b32 s19, 0x00020000
  s_mov_b32 s22, 8388608
  s_mov_b32 s23, 0x00020000
  s_mov_b32 s26, 8388608
  s_mov_b32 s27, 0x00020000
  s_waitcnt lgkmcnt(0)
  s_mov_b32 s12, s4
  s_and_b32 s13, s5, 0xffff
  s_mov_b32 s16, s6
  s_and_b32 s17, s7, 0xffff
  s_mov_b32 s20, s8
  s_and_b32 s21, s9, 0xffff
  s_mov_b32 s24, s10
  s_and_b32 s25, s11, 0xffff
  s_cmp_eq_u32 s29, 4
  s_cbranch_scc0 L_compute
  s_barrier
  s_mov_b32 s35, 0
L_ld0:
  s_mov_b32 m0, s32
  s_nop 0
  buffer_load_dwordx4 v11, s[16:19], s31 offen lds
  buffer_load_dwordx4 v11, s[16:19], s31 offen offset:1024 lds
  s_add_u32 m0, s32, 16384
  s_add_u32 s32, s32, 2048
  buffer_load_dwordx4 v12, s[20:23], s31 offen lds
  buffer_load_dwordx4 v12, s[20:23], s31 offen offset:1024 lds
  s_add_u32 s31, s31, 2048
  s_add_u32 s35, s35, 1
  s_cmp_lt_u32 s35, 4
  s_cbranch_scc1 L_ld0
  s_add_u32 s32, s32, 16384
  s_and_b32 s32, s32, 0x1ffff
  s_barrier
  s_waitcnt vmcnt(0)
  s_barrier
  s_mov_b32 s33, 1
L_ld:
  s_mov_b32 s35, 0
L_ld1:
  s_mov_b32 m0, s32
  s_nop 0
  buffer_load_dwordx4 v11, s[16:19], s31 offen lds
  buffer_load_dwordx4 v11, s[16:19], s31 offen offset:1024 lds
  s_add_u32 m0, s32, 16384
  s_add_u32 s32, s32, 2048
  buffer_load_dwordx4 v12, s[20:23], s31 offen lds
  buffer_load_dwordx4 v12, s[20:23], s31 offen offset:1024 lds
  s_add_u32 s31, s31, 2048
  s_add_u32 s35, s35, 1
  s_cmp_lt_u32 s35, 8
  s_cbranch_scc1 L_ld1
  s_add_u32 s32, s32, 16384
  s_and_b32 s32, s32, 0x1ffff
  s_waitcnt vmcnt(0)
  s_barrier
  s_add_u32 s33, s33, 1
  s_cmp_lt_u32 s33, 8
  s_cbranch_scc1 L_ld
  s_endpgm
L_compute:
  buffer_load_dwordx4 v[44:47], v10, s[12:15], s30 offen offset:0
  buffer_load_dwordx4 v[48:51], v10, s[12:15], s30 offen offset:32
  s_mov_b32 m0, s32
  s_nop 0
  buffer_load_dwordx4 v11, s[16:19], s31 offen lds
  buffer_load_dwordx4 v11, s[16:19], s31 offen offset:1024 lds
  s_add_u32 m0, s32, 16384
  s_add_u32 s32, s32, 2048
  buffer_load_dwordx4 v12, s[20:23], s31 offen lds
  buffer_load_dwordx4 v12, s[20:23], s31 offen offset:1024 lds
  s_add_u32 s31, s31, 2048
  buffer_load_dwordx4 v[52:55], v10, s[12:15], s30 offen offset:2048
  buffer_load_dwordx4 v[56:59], v10, s[12:15], s30 offen offset:2080
  v_lshrrev_b32 v6, 2, v3
  v_and_b32 v6, 3, v6
  v_xor_b32 v6, v6, v4
  v_lshl_add_u32 v13, v6, 4, v5
  v_xor_b32 v14, 32, v13
  v_and_b32 v6, 15, v2
  v_lshrrev_b32 v7, 2, v6
  v_lshl_add_u32 v7, v4, 3, v7
  v_lshlrev_b32 v7, 6, v7
  v_and_b32 v6, 3, v6
  v_lshl_add_u32 v7, v6, 3, v7
  v_bfe_u32 v6, v2, 4, 1
  v_lshl_add_u32 v15, v6, 5, v7
  v_mov_b32 v16, v13
  v_mov_b32 v17, v14
  v_mov_b32 v18, v15
  s_barrier
  v_mov_b32 v19, 0xdddddddd
  v_lshlrev_b32 v6, 9, v4
  v_lshl_add_u32 v20, v3, 1, v6
  v_and_b32 v6, 7, v2
  v_cmp_eq_u32 vcc, 0, v6
  v_cmp_eq_u32 s[42:43], 4, v6
  v_mov_b32 v7, 0x3f803f80
  s_mov_b32 s33, 1
  s_mov_b32 s34, 0
  v_cndmask_b32 v24, 0, v7, vcc
  v_cndmask_b32 v25, 0, v7, vcc
  v_cndmask_b32 v26, 0, v7, s[42:43]
  v_cndmask_b32 v27, 0, v7, s[42:43]
  v_mov_b32 v8, 0x3e8293ee
  v_mov_b32 v9, v8
  v_mov_b32 v7, 0x7f800000
  s_mov_b64 s[40:41], -1
  v_mov_b64 v[76:77], 0
  v_mov_b64 v[78:79], 0
  v_mov_b64 v[80:81], 0
  v_mov_b64 v[82:83], 0
  v_mov_b64 v[84:85], 0
  v_mov_b64 v[86:87], 0
  v_mov_b64 v[88:89], 0
  v_mov_b64 v[90:91], 0
  v_mov_b64 v[92:93], 0
  v_mov_b64 v[94:95], 0
  v_mov_b64 v[96:97], 0
  v_mov_b64 v[98:99], 0
  v_mov_b64 v[100:101], 0
  v_mov_b64 v[102:103], 0
  v_mov_b64 v[104:105], 0
  v_mov_b64 v[106:107], 0
  v_mov_b64 v[108:109], 0
  v_mov_b64 v[110:111], 0
  v_mov_b64 v[112:113], 0
  v_mov_b64 v[114:115], 0
  v_mov_b64 v[116:117], 0
  v_mov_b64 v[118:119], 0
  v_mov_b64 v[120:121], 0
  v_mov_b64 v[122:123], 0
  v_mov_b64 v[124:125], 0
  v_mov_b64 v[126:127], 0
  v_mov_b64 v[128:129], 0
  v_mov_b64 v[130:131], 0
  v_mov_b64 v[132:133], 0
  v_mov_b64 v[134:135], 0
  v_mov_b64 v[136:137], 0
  v_mov_b64 v[138:139], 0
  v_mov_b64 v[140:141], 0
  v_mov_b64 v[142:143], 0
  v_mov_b64 v[144:145], 0
  v_mov_b64 v[146:147], 0
  v_mov_b64 v[148:149], 0
  v_mov_b64 v[150:151], 0
  v_mov_b64 v[152:153], 0
  v_mov_b64 v[154:155], 0
  v_mov_b64 v[212:213], 0
  v_mov_b64 v[214:215], 0
  v_mov_b64 v[216:217], 0
  v_mov_b64 v[218:219], 0
  v_mov_b64 v[248:249], 0
  v_mov_b64 v[250:251], 0
  s_waitcnt vmcnt(6)
  v_lshlrev_b32 v28, 16, v44
  v_and_b32 v29, 0xffff0000, v44
  v_lshlrev_b32 v30, 16, v45
  v_and_b32 v31, 0xffff0000, v45
  v_lshlrev_b32 v32, 16, v46
  v_and_b32 v33, 0xffff0000, v46
  v_lshlrev_b32 v34, 16, v47
  v_and_b32 v35, 0xffff0000, v47
  v_pk_mul_f32 v[28:29], v[28:29], v[8:9]
  v_pk_mul_f32 v[30:31], v[30:31], v[8:9]
  v_pk_mul_f32 v[32:33], v[32:33], v[8:9]
  v_pk_mul_f32 v[34:35], v[34:35], v[8:9]
  v_cvt_pk_bf16_f32 v44, v28, v29
  v_cvt_pk_bf16_f32 v45, v30, v31
  v_cvt_pk_bf16_f32 v46, v32, v33
  v_cvt_pk_bf16_f32 v47, v34, v35
  v_lshlrev_b32 v36, 16, v48
  v_and_b32 v37, 0xffff0000, v48
  v_lshlrev_b32 v38, 16, v49
  v_and_b32 v39, 0xffff0000, v49
  v_lshlrev_b32 v40, 16, v50
  v_and_b32 v41, 0xffff0000, v50
  v_lshlrev_b32 v42, 16, v51
  v_and_b32 v43, 0xffff0000, v51
  v_pk_mul_f32 v[36:37], v[36:37], v[8:9]
  v_pk_mul_f32 v[38:39], v[38:39], v[8:9]
  v_pk_mul_f32 v[40:41], v[40:41], v[8:9]
  v_pk_mul_f32 v[42:43], v[42:43], v[8:9]
  v_cvt_pk_bf16_f32 v48, v36, v37
  v_cvt_pk_bf16_f32 v49, v38, v39
  v_cvt_pk_bf16_f32 v50, v40, v41
  v_cvt_pk_bf16_f32 v51, v42, v43
  s_waitcnt vmcnt(2)
  s_barrier
  ds_read_b128 v[220:223], v16 offset:0
  ds_read_b128 v[224:227], v17 offset:0
  ds_read_b64_tr_b16 v[236:237], v18 offset:16384
  ds_read_b64_tr_b16 v[238:239], v18 offset:16640
  ds_read_b64_tr_b16 v[240:241], v18 offset:17408
  ds_read_b64_tr_b16 v[242:243], v18 offset:17664
  ds_read_b128 v[228:231], v16 offset:2048
  ds_read_b128 v[232:235], v17 offset:2048
  s_waitcnt vmcnt(0)
  buffer_load_dwordx4 v[60:63], v10, s[12:15], s37 offen offset:0
  buffer_load_dwordx4 v[64:67], v10, s[12:15], s37 offen offset:32
  buffer_load_dwordx4 v[68:71], v10, s[12:15], s37 offen offset:2048
  buffer_load_dwordx4 v[72:75], v10, s[12:15], s37 offen offset:2080
  v_lshlrev_b32 v28, 16, v52
  v_and_b32 v29, 0xffff0000, v52
  v_lshlrev_b32 v30, 16, v53
  v_and_b32 v31, 0xffff0000, v53
  v_lshlrev_b32 v32, 16, v54
  v_and_b32 v33, 0xffff0000, v54
  v_lshlrev_b32 v34, 16, v55
  v_and_b32 v35, 0xffff0000, v55
  s_waitcnt lgkmcnt(6)
  v_mfma_f32_32x32x16_bf16 v[156:171], v[220:223], v[44:47], 4.0
  v_mfma_f32_32x32x16_bf16 v[156:171], v[224:227], v[48:51], v[156:171]
  v_pk_mul_f32 v[28:29], v[28:29], v[8:9]
  v_pk_mul_f32 v[30:31], v[30:31], v[8:9]
  v_pk_mul_f32 v[32:33], v[32:33], v[8:9]
  v_pk_mul_f32 v[34:35], v[34:35], v[8:9]
  v_cvt_pk_bf16_f32 v52, v28, v29
  v_cvt_pk_bf16_f32 v53, v30, v31
  v_cvt_pk_bf16_f32 v54, v32, v33
  v_cvt_pk_bf16_f32 v55, v34, v35
  v_lshlrev_b32 v36, 16, v56
  v_and_b32 v37, 0xffff0000, v56
  v_lshlrev_b32 v38, 16, v57
  v_and_b32 v39, 0xffff0000, v57
  v_lshlrev_b32 v40, 16, v58
  v_and_b32 v41, 0xffff0000, v58
  v_lshlrev_b32 v42, 16, v59
  v_and_b32 v43, 0xffff0000, v59
  v_pk_mul_f32 v[36:37], v[36:37], v[8:9]
  v_pk_mul_f32 v[38:39], v[38:39], v[8:9]
  v_pk_mul_f32 v[40:41], v[40:41], v[8:9]
  v_pk_mul_f32 v[42:43], v[42:43], v[8:9]
  v_cvt_pk_bf16_f32 v56, v36, v37
  v_cvt_pk_bf16_f32 v57, v38, v39
  v_cvt_pk_bf16_f32 v58, v40, v41
  v_cvt_pk_bf16_f32 v59, v42, v43
  s_nop 1
  v_mfma_f32_32x32x16_bf16 v[172:187], v[220:223], v[52:55], 4.0
  v_exp_f32 v156, v156
  v_exp_f32 v157, v157
  v_exp_f32 v158, v158
  v_mfma_f32_32x32x16_bf16 v[172:187], v[224:227], v[56:59], v[172:187]
  v_exp_f32 v159, v159
  v_exp_f32 v160, v160
  v_exp_f32 v161, v161
  v_smfmac_f32_32x32x32_bf16 v[124:139], v[248:251], v[212:219], v19
  v_exp_f32 v162, v162
  v_exp_f32 v163, v163
  v_exp_f32 v164, v164
  v_smfmac_f32_16x16x64_bf16 v[152:155], v[24:27], v[212:219], v19
  v_exp_f32 v165, v165
  v_exp_f32 v166, v166
  s_waitcnt lgkmcnt(2)
  v_smfmac_f32_32x32x32_bf16 v[76:91], v[236:239], v[156:163], v19
  v_exp_f32 v167, v167
  v_exp_f32 v168, v168
  v_exp_f32 v169, v169
  v_smfmac_f32_16x16x64_bf16 v[140:143], v[24:27], v[156:163], v19
  v_exp_f32 v170, v170
  v_exp_f32 v171, v171
  s_waitcnt lgkmcnt(0)
  v_mfma_f32_32x32x16_bf16 v[188:203], v[228:231], v[44:47], 4.0
  ds_read_b64_tr_b16 v[244:245], v18 offset:18432
  v_exp_f32 v172, v172
  v_exp_f32 v173, v173
  v_exp_f32 v174, v174
  v_mfma_f32_32x32x16_bf16 v[188:203], v[232:235], v[48:51], v[188:203]
  ds_read_b64_tr_b16 v[246:247], v18 offset:18688
  v_exp_f32 v175, v175
  v_exp_f32 v176, v176
  v_exp_f32 v177, v177
  v_smfmac_f32_32x32x32_bf16 v[76:91], v[240:243], v[164:171], v19
  ds_read_b64_tr_b16 v[248:249], v18 offset:19456
  v_exp_f32 v178, v178
  v_exp_f32 v179, v179
  v_exp_f32 v180, v180
  v_smfmac_f32_16x16x64_bf16 v[140:143], v[24:27], v[164:171], v19
  ds_read_b64_tr_b16 v[250:251], v18 offset:19712
  v_exp_f32 v181, v181
  v_exp_f32 v182, v182
  v_smfmac_f32_32x32x32_bf16 v[92:107], v[236:239], v[172:179], v19
  ds_read_b128 v[220:223], v16 offset:4096
  v_exp_f32 v183, v183
  v_exp_f32 v184, v184
  v_exp_f32 v185, v185
  v_smfmac_f32_16x16x64_bf16 v[144:147], v[24:27], v[172:179], v19
  ds_read_b128 v[224:227], v17 offset:4096
  v_exp_f32 v186, v186
  v_exp_f32 v187, v187
  v_mfma_f32_32x32x16_bf16 v[204:219], v[228:231], v[52:55], 4.0
  v_exp_f32 v188, v188
  v_exp_f32 v189, v189
  v_exp_f32 v190, v190
  v_mfma_f32_32x32x16_bf16 v[204:219], v[232:235], v[56:59], v[204:219]
  v_exp_f32 v191, v191
  v_exp_f32 v192, v192
  v_exp_f32 v193, v193
  v_smfmac_f32_32x32x32_bf16 v[92:107], v[240:243], v[180:187], v19
  v_exp_f32 v194, v194
  v_exp_f32 v195, v195
  v_exp_f32 v196, v196
  v_smfmac_f32_16x16x64_bf16 v[144:147], v[24:27], v[180:187], v19
  v_exp_f32 v197, v197
  v_exp_f32 v198, v198
  s_waitcnt lgkmcnt(2)
  v_smfmac_f32_32x32x32_bf16 v[76:91], v[244:247], v[188:195], v19
  v_exp_f32 v199, v199
  v_exp_f32 v200, v200
  v_exp_f32 v201, v201
  v_smfmac_f32_16x16x64_bf16 v[140:143], v[24:27], v[188:195], v19
  v_exp_f32 v202, v202
  v_exp_f32 v203, v203
  s_waitcnt lgkmcnt(0)
  v_mfma_f32_32x32x16_bf16 v[156:171], v[220:223], v[44:47], 4.0
  ds_read_b64_tr_b16 v[236:237], v18 offset:20480
  v_exp_f32 v204, v204
  v_exp_f32 v205, v205
  v_exp_f32 v206, v206
  v_mfma_f32_32x32x16_bf16 v[156:171], v[224:227], v[48:51], v[156:171]
  ds_read_b64_tr_b16 v[238:239], v18 offset:20736
  v_exp_f32 v207, v207
  v_exp_f32 v208, v208
  v_exp_f32 v209, v209
  v_smfmac_f32_32x32x32_bf16 v[76:91], v[248:251], v[196:203], v19
  ds_read_b64_tr_b16 v[240:241], v18 offset:21504
  v_exp_f32 v210, v210
  v_exp_f32 v211, v211
  v_exp_f32 v212, v212
  v_smfmac_f32_16x16x64_bf16 v[140:143], v[24:27], v[196:203], v19
  ds_read_b64_tr_b16 v[242:243], v18 offset:21760
  v_exp_f32 v213, v213
  v_exp_f32 v214, v214
  v_smfmac_f32_32x32x32_bf16 v[92:107], v[244:247], v[204:211], v19
  ds_read_b128 v[228:231], v16 offset:6144
  v_exp_f32 v215, v215
  v_exp_f32 v216, v216
  v_exp_f32 v217, v217
  v_smfmac_f32_16x16x64_bf16 v[144:147], v[24:27], v[204:211], v19
  ds_read_b128 v[232:235], v17 offset:6144
  v_exp_f32 v218, v218
  v_exp_f32 v219, v219
  v_mfma_f32_32x32x16_bf16 v[172:187], v[220:223], v[52:55], 4.0
  v_exp_f32 v156, v156
  v_exp_f32 v157, v157
  v_exp_f32 v158, v158
  v_mfma_f32_32x32x16_bf16 v[172:187], v[224:227], v[56:59], v[172:187]
  v_exp_f32 v159, v159
  v_exp_f32 v160, v160
  v_exp_f32 v161, v161
  v_smfmac_f32_32x32x32_bf16 v[92:107], v[248:251], v[212:219], v19
  v_exp_f32 v162, v162
  v_exp_f32 v163, v163
  v_exp_f32 v164, v164
  v_smfmac_f32_16x16x64_bf16 v[144:147], v[24:27], v[212:219], v19
  v_exp_f32 v165, v165
  v_exp_f32 v166, v166
  s_waitcnt lgkmcnt(2)
  v_smfmac_f32_32x32x32_bf16 v[76:91], v[236:239], v[156:163], v19
  v_exp_f32 v167, v167
  v_exp_f32 v168, v168
  v_exp_f32 v169, v169
  v_smfmac_f32_16x16x64_bf16 v[140:143], v[24:27], v[156:163], v19
  v_exp_f32 v170, v170
  v_exp_f32 v171, v171
  s_barrier
  s_waitcnt lgkmcnt(0)
  v_mfma_f32_32x32x16_bf16 v[188:203], v[228:231], v[44:47], 4.0
  ds_read_b64_tr_b16 v[244:245], v18 offset:22528
  v_exp_f32 v172, v172
  v_exp_f32 v173, v173
  v_exp_f32 v174, v174
  v_mfma_f32_32x32x16_bf16 v[188:203], v[232:235], v[48:51], v[188:203]
  ds_read_b64_tr_b16 v[246:247], v18 offset:22784
  v_exp_f32 v175, v175
  v_exp_f32 v176, v176
  v_exp_f32 v177, v177
  v_smfmac_f32_32x32x32_bf16 v[76:91], v[240:243], v[164:171], v19
  ds_read_b64_tr_b16 v[248:249], v18 offset:23552
  v_exp_f32 v178, v178
  v_exp_f32 v179, v179
  v_exp_f32 v180, v180
  v_smfmac_f32_16x16x64_bf16 v[140:143], v[24:27], v[164:171], v19
  ds_read_b64_tr_b16 v[250:251], v18 offset:23808
  v_exp_f32 v181, v181
  v_exp_f32 v182, v182
  v_smfmac_f32_32x32x32_bf16 v[92:107], v[236:239], v[172:179], v19
  ds_read_b128 v[220:223], v16 offset:8192
  v_exp_f32 v183, v183
  v_exp_f32 v184, v184
  v_exp_f32 v185, v185
  v_smfmac_f32_16x16x64_bf16 v[144:147], v[24:27], v[172:179], v19
  ds_read_b128 v[224:227], v17 offset:8192
  v_exp_f32 v186, v186
  v_exp_f32 v187, v187
  v_mfma_f32_32x32x16_bf16 v[204:219], v[228:231], v[52:55], 4.0
  v_exp_f32 v188, v188
  v_exp_f32 v189, v189
  v_exp_f32 v190, v190
  v_mfma_f32_32x32x16_bf16 v[204:219], v[232:235], v[56:59], v[204:219]
  v_exp_f32 v191, v191
  v_exp_f32 v192, v192
  v_exp_f32 v193, v193
  v_smfmac_f32_32x32x32_bf16 v[92:107], v[240:243], v[180:187], v19
  v_exp_f32 v194, v194
  v_exp_f32 v195, v195
  v_exp_f32 v196, v196
  v_smfmac_f32_16x16x64_bf16 v[144:147], v[24:27], v[180:187], v19
  v_exp_f32 v197, v197
  v_exp_f32 v198, v198
  s_waitcnt lgkmcnt(2)
  v_smfmac_f32_32x32x32_bf16 v[76:91], v[244:247], v[188:195], v19
  v_exp_f32 v199, v199
  v_exp_f32 v200, v200
  v_exp_f32 v201, v201
  v_smfmac_f32_16x16x64_bf16 v[140:143], v[24:27], v[188:195], v19
  v_exp_f32 v202, v202
  v_exp_f32 v203, v203
  s_waitcnt lgkmcnt(0)
  v_mfma_f32_32x32x16_bf16 v[156:171], v[220:223], v[44:47], 4.0
  ds_read_b64_tr_b16 v[236:237], v18 offset:24576
  v_exp_f32 v204, v204
  v_exp_f32 v205, v205
  v_exp_f32 v206, v206
  v_mfma_f32_32x32x16_bf16 v[156:171], v[224:227], v[48:51], v[156:171]
  ds_read_b64_tr_b16 v[238:239], v18 offset:24832
  v_exp_f32 v207, v207
  v_exp_f32 v208, v208
  v_exp_f32 v209, v209
  v_smfmac_f32_32x32x32_bf16 v[76:91], v[248:251], v[196:203], v19
  ds_read_b64_tr_b16 v[240:241], v18 offset:25600
  v_exp_f32 v210, v210
  v_exp_f32 v211, v211
  v_exp_f32 v212, v212
  v_smfmac_f32_16x16x64_bf16 v[140:143], v[24:27], v[196:203], v19
  ds_read_b64_tr_b16 v[242:243], v18 offset:25856
  v_exp_f32 v213, v213
  v_exp_f32 v214, v214
  v_smfmac_f32_32x32x32_bf16 v[92:107], v[244:247], v[204:211], v19
  ds_read_b128 v[228:231], v16 offset:10240
  v_exp_f32 v215, v215
  v_exp_f32 v216, v216
  v_exp_f32 v217, v217
  v_smfmac_f32_16x16x64_bf16 v[144:147], v[24:27], v[204:211], v19
  ds_read_b128 v[232:235], v17 offset:10240
  v_exp_f32 v218, v218
  v_exp_f32 v219, v219
  v_mfma_f32_32x32x16_bf16 v[172:187], v[220:223], v[52:55], 4.0
  v_exp_f32 v156, v156
  v_exp_f32 v157, v157
  v_exp_f32 v158, v158
  v_mfma_f32_32x32x16_bf16 v[172:187], v[224:227], v[56:59], v[172:187]
  v_exp_f32 v159, v159
  v_exp_f32 v160, v160
  v_exp_f32 v161, v161
  v_smfmac_f32_32x32x32_bf16 v[92:107], v[248:251], v[212:219], v19
  v_exp_f32 v162, v162
  v_exp_f32 v163, v163
  v_exp_f32 v164, v164
  v_smfmac_f32_16x16x64_bf16 v[144:147], v[24:27], v[212:219], v19
  v_exp_f32 v165, v165
  v_exp_f32 v166, v166
  s_waitcnt lgkmcnt(2)
  v_smfmac_f32_32x32x32_bf16 v[76:91], v[236:239], v[156:163], v19
  v_exp_f32 v167, v167
  v_exp_f32 v168, v168
  v_exp_f32 v169, v169
  v_smfmac_f32_16x16x64_bf16 v[140:143], v[24:27], v[156:163], v19
  v_exp_f32 v170, v170
  v_exp_f32 v171, v171
  s_waitcnt lgkmcnt(0)
  v_mfma_f32_32x32x16_bf16 v[188:203], v[228:231], v[44:47], 4.0
  ds_read_b64_tr_b16 v[244:245], v18 offset:26624
  v_exp_f32 v172, v172
  v_exp_f32 v173, v173
  v_exp_f32 v174, v174
  v_mfma_f32_32x32x16_bf16 v[188:203], v[232:235], v[48:51], v[188:203]
  ds_read_b64_tr_b16 v[246:247], v18 offset:26880
  v_exp_f32 v175, v175
  v_exp_f32 v176, v176
  v_exp_f32 v177, v177
  v_smfmac_f32_32x32x32_bf16 v[76:91], v[240:243], v[164:171], v19
  ds_read_b64_tr_b16 v[248:249], v18 offset:27648
  v_exp_f32 v178, v178
  v_exp_f32 v179, v179
  v_exp_f32 v180, v180
  v_smfmac_f32_16x16x64_bf16 v[140:143], v[24:27], v[164:171], v19
  ds_read_b64_tr_b16 v[250:251], v18 offset:27904
  v_exp_f32 v181, v181
  v_exp_f32 v182, v182
  v_smfmac_f32_32x32x32_bf16 v[92:107], v[236:239], v[172:179], v19
  ds_read_b128 v[220:223], v16 offset:12288
  v_exp_f32 v183, v183
  v_exp_f32 v184, v184
  v_exp_f32 v185, v185
  v_smfmac_f32_16x16x64_bf16 v[144:147], v[24:27], v[172:179], v19
  ds_read_b128 v[224:227], v17 offset:12288
  v_exp_f32 v186, v186
  v_exp_f32 v187, v187
  v_mfma_f32_32x32x16_bf16 v[204:219], v[228:231], v[52:55], 4.0
  v_exp_f32 v188, v188
  v_exp_f32 v189, v189
  v_exp_f32 v190, v190
  v_mfma_f32_32x32x16_bf16 v[204:219], v[232:235], v[56:59], v[204:219]
  v_exp_f32 v191, v191
  v_exp_f32 v192, v192
  v_exp_f32 v193, v193
  v_smfmac_f32_32x32x32_bf16 v[92:107], v[240:243], v[180:187], v19
  v_exp_f32 v194, v194
  v_exp_f32 v195, v195
  v_exp_f32 v196, v196
  v_smfmac_f32_16x16x64_bf16 v[144:147], v[24:27], v[180:187], v19
  v_exp_f32 v197, v197
  v_exp_f32 v198, v198
  s_waitcnt lgkmcnt(2)
  v_smfmac_f32_32x32x32_bf16 v[76:91], v[244:247], v[188:195], v19
  v_exp_f32 v199, v199
  v_exp_f32 v200, v200
  v_exp_f32 v201, v201
  v_smfmac_f32_16x16x64_bf16 v[140:143], v[24:27], v[188:195], v19
  v_exp_f32 v202, v202
  v_exp_f32 v203, v203
  s_waitcnt lgkmcnt(0)
  v_mfma_f32_32x32x16_bf16 v[156:171], v[220:223], v[44:47], 4.0
  ds_read_b64_tr_b16 v[236:237], v18 offset:28672
  v_exp_f32 v204, v204
  v_exp_f32 v205, v205
  v_exp_f32 v206, v206
  v_mfma_f32_32x32x16_bf16 v[156:171], v[224:227], v[48:51], v[156:171]
  ds_read_b64_tr_b16 v[238:239], v18 offset:28928
  v_exp_f32 v207, v207
  v_exp_f32 v208, v208
  v_exp_f32 v209, v209
  v_smfmac_f32_32x32x32_bf16 v[76:91], v[248:251], v[196:203], v19
  ds_read_b64_tr_b16 v[240:241], v18 offset:29696
  v_exp_f32 v210, v210
  v_exp_f32 v211, v211
  v_exp_f32 v212, v212
  v_smfmac_f32_16x16x64_bf16 v[140:143], v[24:27], v[196:203], v19
  ds_read_b64_tr_b16 v[242:243], v18 offset:29952
  v_exp_f32 v213, v213
  v_exp_f32 v214, v214
  v_smfmac_f32_32x32x32_bf16 v[92:107], v[244:247], v[204:211], v19
  ds_read_b128 v[228:231], v16 offset:14336
  v_exp_f32 v215, v215
  v_exp_f32 v216, v216
  v_exp_f32 v217, v217
  v_smfmac_f32_16x16x64_bf16 v[144:147], v[24:27], v[204:211], v19
  ds_read_b128 v[232:235], v17 offset:14336
  v_exp_f32 v218, v218
  v_exp_f32 v219, v219
  v_mfma_f32_32x32x16_bf16 v[172:187], v[220:223], v[52:55], 4.0
  v_exp_f32 v156, v156
  v_exp_f32 v157, v157
  v_exp_f32 v158, v158
  v_mfma_f32_32x32x16_bf16 v[172:187], v[224:227], v[56:59], v[172:187]
  v_exp_f32 v159, v159
  v_exp_f32 v160, v160
  v_exp_f32 v161, v161
  v_smfmac_f32_32x32x32_bf16 v[92:107], v[248:251], v[212:219], v19
  v_exp_f32 v162, v162
  v_exp_f32 v163, v163
  v_exp_f32 v164, v164
  v_smfmac_f32_16x16x64_bf16 v[144:147], v[24:27], v[212:219], v19
  v_exp_f32 v165, v165
  v_exp_f32 v166, v166
  s_waitcnt lgkmcnt(2)
  v_smfmac_f32_32x32x32_bf16 v[76:91], v[236:239], v[156:163], v19
  v_exp_f32 v167, v167
  v_exp_f32 v168, v168
  v_exp_f32 v169, v169
  v_smfmac_f32_16x16x64_bf16 v[140:143], v[24:27], v[156:163], v19
  v_exp_f32 v170, v170
  v_exp_f32 v171, v171
  s_waitcnt vmcnt(2)
  s_waitcnt lgkmcnt(0)
  v_mfma_f32_32x32x16_bf16 v[188:203], v[228:231], v[44:47], 4.0
  ds_read_b64_tr_b16 v[244:245], v18 offset:30720
  v_exp_f32 v172, v172
  v_exp_f32 v173, v173
  v_exp_f32 v174, v174
  v_lshlrev_b32 v28, 16, v60
  v_and_b32 v29, 0xffff0000, v60
  v_mfma_f32_32x32x16_bf16 v[188:203], v[232:235], v[48:51], v[188:203]
  ds_read_b64_tr_b16 v[246:247], v18 offset:30976
  v_exp_f32 v175, v175
  v_exp_f32 v176, v176
  v_exp_f32 v177, v177
  v_lshlrev_b32 v30, 16, v61
  v_and_b32 v31, 0xffff0000, v61
  v_smfmac_f32_32x32x32_bf16 v[76:91], v[240:243], v[164:171], v19
  ds_read_b64_tr_b16 v[248:249], v18 offset:31744
  v_exp_f32 v178, v178
  v_exp_f32 v179, v179
  v_exp_f32 v180, v180
  v_lshlrev_b32 v32, 16, v62
  v_and_b32 v33, 0xffff0000, v62
  v_smfmac_f32_16x16x64_bf16 v[140:143], v[24:27], v[164:171], v19
  ds_read_b64_tr_b16 v[250:251], v18 offset:32000
  v_exp_f32 v181, v181
  v_lshlrev_b32 v34, 16, v63
  v_and_b32 v35, 0xffff0000, v63
  v_exp_f32 v182, v182
  v_pk_mul_f32 v[28:29], v[28:29], v[8:9]
  v_pk_mul_f32 v[30:31], v[30:31], v[8:9]
  v_smfmac_f32_32x32x32_bf16 v[92:107], v[236:239], v[172:179], v19
  ds_read_b128 v[220:223], v16 offset:0
  v_exp_f32 v183, v183
  v_exp_f32 v184, v184
  v_pk_mul_f32 v[32:33], v[32:33], v[8:9]
  v_pk_mul_f32 v[34:35], v[34:35], v[8:9]
  v_exp_f32 v185, v185
  v_cvt_pk_bf16_f32 v60, v28, v29
  v_cvt_pk_bf16_f32 v61, v30, v31
  v_smfmac_f32_16x16x64_bf16 v[144:147], v[24:27], v[172:179], v19
  ds_read_b128 v[224:227], v17 offset:0
  v_exp_f32 v186, v186
  v_cvt_pk_bf16_f32 v62, v32, v33
  v_cvt_pk_bf16_f32 v63, v34, v35
  v_exp_f32 v187, v187
  v_mfma_f32_32x32x16_bf16 v[204:219], v[228:231], v[52:55], 4.0
  v_exp_f32 v188, v188
  v_exp_f32 v189, v189
  v_exp_f32 v190, v190
  v_lshlrev_b32 v36, 16, v64
  v_and_b32 v37, 0xffff0000, v64
  v_mfma_f32_32x32x16_bf16 v[204:219], v[232:235], v[56:59], v[204:219]
  v_exp_f32 v191, v191
  v_exp_f32 v192, v192
  v_exp_f32 v193, v193
  v_lshlrev_b32 v38, 16, v65
  v_and_b32 v39, 0xffff0000, v65
  v_smfmac_f32_32x32x32_bf16 v[92:107], v[240:243], v[180:187], v19
  v_exp_f32 v194, v194
  v_exp_f32 v195, v195
  v_exp_f32 v196, v196
  v_lshlrev_b32 v40, 16, v66
  v_and_b32 v41, 0xffff0000, v66
  v_smfmac_f32_16x16x64_bf16 v[144:147], v[24:27], v[180:187], v19
  v_exp_f32 v197, v197
  v_lshlrev_b32 v42, 16, v67
  v_and_b32 v43, 0xffff0000, v67
  v_exp_f32 v198, v198
  v_pk_mul_f32 v[36:37], v[36:37], v[8:9]
  v_pk_mul_f32 v[38:39], v[38:39], v[8:9]
  s_waitcnt lgkmcnt(2)
  v_smfmac_f32_32x32x32_bf16 v[76:91], v[244:247], v[188:195], v19
  v_exp_f32 v199, v199
  v_exp_f32 v200, v200
  v_pk_mul_f32 v[40:41], v[40:41], v[8:9]
  v_pk_mul_f32 v[42:43], v[42:43], v[8:9]
  v_exp_f32 v201, v201
  v_cvt_pk_bf16_f32 v64, v36, v37
  v_cvt_pk_bf16_f32 v65, v38, v39
  v_smfmac_f32_16x16x64_bf16 v[140:143], v[24:27], v[188:195], v19
  v_exp_f32 v202, v202
  v_cvt_pk_bf16_f32 v66, v40, v41
  v_cvt_pk_bf16_f32 v67, v42, v43
  v_exp_f32 v203, v203
  s_waitcnt vmcnt(0)
  s_waitcnt lgkmcnt(0)
  v_mfma_f32_32x32x16_bf16 v[156:171], v[220:223], v[60:63], 4.0
  ds_read_b64_tr_b16 v[236:237], v18 offset:16384
  v_exp_f32 v204, v204
  v_lshlrev_b32 v28, 16, v68
  v_and_b32 v29, 0xffff0000, v68
  v_lshlrev_b32 v30, 16, v69
  v_exp_f32 v205, v205
  v_and_b32 v31, 0xffff0000, v69
  v_lshlrev_b32 v32, 16, v70
  v_and_b32 v33, 0xffff0000, v70
  v_exp_f32 v206, v206
  v_lshlrev_b32 v34, 16, v71
  v_and_b32 v35, 0xffff0000, v71
  v_pk_mul_f32 v[28:29], v[28:29], v[8:9]
  v_mfma_f32_32x32x16_bf16 v[156:171], v[224:227], v[64:67], v[156:171]
  ds_read_b64_tr_b16 v[238:239], v18 offset:16640
  v_exp_f32 v207, v207
  v_pk_mul_f32 v[30:31], v[30:31], v[8:9]
  v_pk_mul_f32 v[32:33], v[32:33], v[8:9]
  v_pk_mul_f32 v[34:35], v[34:35], v[8:9]
  v_exp_f32 v208, v208
  v_cvt_pk_bf16_f32 v68, v28, v29
  v_cvt_pk_bf16_f32 v69, v30, v31
  v_cvt_pk_bf16_f32 v70, v32, v33
  v_exp_f32 v209, v209
  v_cvt_pk_bf16_f32 v71, v34, v35
  v_lshlrev_b32 v36, 16, v72
  v_and_b32 v37, 0xffff0000, v72
  v_smfmac_f32_32x32x32_bf16 v[76:91], v[248:251], v[196:203], v19
  ds_read_b64_tr_b16 v[240:241], v18 offset:17408
  v_exp_f32 v210, v210
  v_lshlrev_b32 v38, 16, v73
  v_and_b32 v39, 0xffff0000, v73
  v_lshlrev_b32 v40, 16, v74
  v_exp_f32 v211, v211
  v_and_b32 v41, 0xffff0000, v74
  v_lshlrev_b32 v42, 16, v75
  v_and_b32 v43, 0xffff0000, v75
  v_exp_f32 v212, v212
  v_pk_mul_f32 v[36:37], v[36:37], v[8:9]
  v_pk_mul_f32 v[38:39], v[38:39], v[8:9]
  v_pk_mul_f32 v[40:41], v[40:41], v[8:9]
  v_smfmac_f32_16x16x64_bf16 v[140:143], v[24:27], v[196:203], v19
  ds_read_b64_tr_b16 v[242:243], v18 offset:17664
  v_exp_f32 v213, v213
  v_pk_mul_f32 v[42:43], v[42:43], v[8:9]
  v_cvt_pk_bf16_f32 v72, v36, v37
  v_cvt_pk_bf16_f32 v73, v38, v39
  v_exp_f32 v214, v214
  v_cvt_pk_bf16_f32 v74, v40, v41
  v_cvt_pk_bf16_f32 v75, v42, v43
  v_smfmac_f32_32x32x32_bf16 v[92:107], v[244:247], v[204:211], v19
  ds_read_b128 v[228:231], v16 offset:2048
  v_exp_f32 v215, v215
  v_exp_f32 v216, v216
  v_exp_f32 v217, v217
  v_smfmac_f32_16x16x64_bf16 v[144:147], v[24:27], v[204:211], v19
  ds_read_b128 v[232:235], v17 offset:2048
  v_exp_f32 v218, v218
  v_exp_f32 v219, v219
  v_mfma_f32_32x32x16_bf16 v[172:187], v[220:223], v[68:71], 4.0
  v_exp_f32 v156, v156
  v_exp_f32 v157, v157
  v_exp_f32 v158, v158
  v_mfma_f32_32x32x16_bf16 v[172:187], v[224:227], v[72:75], v[172:187]
  v_exp_f32 v159, v159
  v_exp_f32 v160, v160
  v_exp_f32 v161, v161
  v_smfmac_f32_32x32x32_bf16 v[92:107], v[248:251], v[212:219], v19
  v_exp_f32 v162, v162
  v_exp_f32 v163, v163
  v_exp_f32 v164, v164
  v_smfmac_f32_16x16x64_bf16 v[144:147], v[24:27], v[212:219], v19
  v_exp_f32 v165, v165
  v_exp_f32 v166, v166
  s_waitcnt lgkmcnt(2)
  v_smfmac_f32_32x32x32_bf16 v[108:123], v[236:239], v[156:163], v19
  v_exp_f32 v167, v167
  v_exp_f32 v168, v168
  v_exp_f32 v169, v169
  v_smfmac_f32_16x16x64_bf16 v[148:151], v[24:27], v[156:163], v19
  v_exp_f32 v170, v170
  v_exp_f32 v171, v171
  s_waitcnt lgkmcnt(0)
  v_mfma_f32_32x32x16_bf16 v[188:203], v[228:231], v[60:63], 4.0
  ds_read_b64_tr_b16 v[244:245], v18 offset:18432
  v_exp_f32 v172, v172
  v_exp_f32 v173, v173
  v_exp_f32 v174, v174
  v_mfma_f32_32x32x16_bf16 v[188:203], v[232:235], v[64:67], v[188:203]
  ds_read_b64_tr_b16 v[246:247], v18 offset:18688
  v_exp_f32 v175, v175
  v_exp_f32 v176, v176
  v_exp_f32 v177, v177
  v_smfmac_f32_32x32x32_bf16 v[108:123], v[240:243], v[164:171], v19
  ds_read_b64_tr_b16 v[248:249], v18 offset:19456
  v_exp_f32 v178, v178
  v_exp_f32 v179, v179
  v_exp_f32 v180, v180
  v_smfmac_f32_16x16x64_bf16 v[148:151], v[24:27], v[164:171], v19
  ds_read_b64_tr_b16 v[250:251], v18 offset:19712
  v_exp_f32 v181, v181
  v_exp_f32 v182, v182
  v_smfmac_f32_32x32x32_bf16 v[124:139], v[236:239], v[172:179], v19
  ds_read_b128 v[220:223], v16 offset:4096
  v_exp_f32 v183, v183
  v_exp_f32 v184, v184
  v_exp_f32 v185, v185
  v_smfmac_f32_16x16x64_bf16 v[152:155], v[24:27], v[172:179], v19
  ds_read_b128 v[224:227], v17 offset:4096
  v_exp_f32 v186, v186
  v_exp_f32 v187, v187
  v_mfma_f32_32x32x16_bf16 v[204:219], v[228:231], v[68:71], 4.0
  v_exp_f32 v188, v188
  v_exp_f32 v189, v189
  v_exp_f32 v190, v190
  v_mfma_f32_32x32x16_bf16 v[204:219], v[232:235], v[72:75], v[204:219]
  v_exp_f32 v191, v191
  v_exp_f32 v192, v192
  v_exp_f32 v193, v193
  v_smfmac_f32_32x32x32_bf16 v[124:139], v[240:243], v[180:187], v19
  v_exp_f32 v194, v194
  v_exp_f32 v195, v195
  v_exp_f32 v196, v196
  v_smfmac_f32_16x16x64_bf16 v[152:155], v[24:27], v[180:187], v19
  v_exp_f32 v197, v197
  v_exp_f32 v198, v198
  s_waitcnt lgkmcnt(2)
  v_smfmac_f32_32x32x32_bf16 v[108:123], v[244:247], v[188:195], v19
  v_exp_f32 v199, v199
  v_exp_f32 v200, v200
  v_exp_f32 v201, v201
  v_smfmac_f32_16x16x64_bf16 v[148:151], v[24:27], v[188:195], v19
  v_exp_f32 v202, v202
  v_exp_f32 v203, v203
  s_waitcnt lgkmcnt(0)
  v_mfma_f32_32x32x16_bf16 v[156:171], v[220:223], v[60:63], 4.0
  ds_read_b64_tr_b16 v[236:237], v18 offset:20480
  v_exp_f32 v204, v204
  v_exp_f32 v205, v205
  v_exp_f32 v206, v206
  v_mfma_f32_32x32x16_bf16 v[156:171], v[224:227], v[64:67], v[156:171]
  ds_read_b64_tr_b16 v[238:239], v18 offset:20736
  v_exp_f32 v207, v207
  v_exp_f32 v208, v208
  v_exp_f32 v209, v209
  v_smfmac_f32_32x32x32_bf16 v[108:123], v[248:251], v[196:203], v19
  ds_read_b64_tr_b16 v[240:241], v18 offset:21504
  v_exp_f32 v210, v210
  v_exp_f32 v211, v211
  v_exp_f32 v212, v212
  v_smfmac_f32_16x16x64_bf16 v[148:151], v[24:27], v[196:203], v19
  ds_read_b64_tr_b16 v[242:243], v18 offset:21760
  v_exp_f32 v213, v213
  v_exp_f32 v214, v214
  v_smfmac_f32_32x32x32_bf16 v[124:139], v[244:247], v[204:211], v19
  ds_read_b128 v[228:231], v16 offset:6144
  v_exp_f32 v215, v215
  v_exp_f32 v216, v216
  v_exp_f32 v217, v217
  v_smfmac_f32_16x16x64_bf16 v[152:155], v[24:27], v[204:211], v19
  ds_read_b128 v[232:235], v17 offset:6144
  v_exp_f32 v218, v218
  v_exp_f32 v219, v219
  v_mfma_f32_32x32x16_bf16 v[172:187], v[220:223], v[68:71], 4.0
  v_exp_f32 v156, v156
  v_exp_f32 v157, v157
  v_exp_f32 v158, v158
  v_mfma_f32_32x32x16_bf16 v[172:187], v[224:227], v[72:75], v[172:187]
  v_exp_f32 v159, v159
  v_exp_f32 v160, v160
  v_exp_f32 v161, v161
  v_smfmac_f32_32x32x32_bf16 v[124:139], v[248:251], v[212:219], v19
  v_exp_f32 v162, v162
  v_exp_f32 v163, v163
  v_exp_f32 v164, v164
  v_smfmac_f32_16x16x64_bf16 v[152:155], v[24:27], v[212:219], v19
  v_exp_f32 v165, v165
  v_exp_f32 v166, v166
  s_waitcnt lgkmcnt(2)
  v_smfmac_f32_32x32x32_bf16 v[108:123], v[236:239], v[156:163], v19
  v_exp_f32 v167, v167
  v_exp_f32 v168, v168
  v_exp_f32 v169, v169
  v_smfmac_f32_16x16x64_bf16 v[148:151], v[24:27], v[156:163], v19
  v_exp_f32 v170, v170
  v_exp_f32 v171, v171
  s_waitcnt lgkmcnt(0)
  v_mfma_f32_32x32x16_bf16 v[188:203], v[228:231], v[60:63], 4.0
  ds_read_b64_tr_b16 v[244:245], v18 offset:22528
  v_exp_f32 v172, v172
  v_exp_f32 v173, v173
  v_exp_f32 v174, v174
  v_mfma_f32_32x32x16_bf16 v[188:203], v[232:235], v[64:67], v[188:203]
  ds_read_b64_tr_b16 v[246:247], v18 offset:22784
  v_exp_f32 v175, v175
  v_exp_f32 v176, v176
  v_exp_f32 v177, v177
  v_smfmac_f32_32x32x32_bf16 v[108:123], v[240:243], v[164:171], v19
  ds_read_b64_tr_b16 v[248:249], v18 offset:23552
  v_exp_f32 v178, v178
  v_exp_f32 v179, v179
  v_exp_f32 v180, v180
  v_smfmac_f32_16x16x64_bf16 v[148:151], v[24:27], v[164:171], v19
  ds_read_b64_tr_b16 v[250:251], v18 offset:23808
  v_exp_f32 v181, v181
  v_exp_f32 v182, v182
  v_smfmac_f32_32x32x32_bf16 v[124:139], v[236:239], v[172:179], v19
  ds_read_b128 v[220:223], v16 offset:8192
  v_exp_f32 v183, v183
  v_exp_f32 v184, v184
  v_exp_f32 v185, v185
  v_smfmac_f32_16x16x64_bf16 v[152:155], v[24:27], v[172:179], v19
  ds_read_b128 v[224:227], v17 offset:8192
  v_exp_f32 v186, v186
  v_exp_f32 v187, v187
  v_mfma_f32_32x32x16_bf16 v[204:219], v[228:231], v[68:71], 4.0
  v_exp_f32 v188, v188
  v_exp_f32 v189, v189
  v_exp_f32 v190, v190
  v_mfma_f32_32x32x16_bf16 v[204:219], v[232:235], v[72:75], v[204:219]
  v_exp_f32 v191, v191
  v_exp_f32 v192, v192
  v_exp_f32 v193, v193
  v_smfmac_f32_32x32x32_bf16 v[124:139], v[240:243], v[180:187], v19
  v_exp_f32 v194, v194
  v_exp_f32 v195, v195
  v_exp_f32 v196, v196
  v_smfmac_f32_16x16x64_bf16 v[152:155], v[24:27], v[180:187], v19
  v_exp_f32 v197, v197
  v_exp_f32 v198, v198
  s_waitcnt lgkmcnt(2)
  v_smfmac_f32_32x32x32_bf16 v[108:123], v[244:247], v[188:195], v19
  v_exp_f32 v199, v199
  v_exp_f32 v200, v200
  v_exp_f32 v201, v201
  v_smfmac_f32_16x16x64_bf16 v[148:151], v[24:27], v[188:195], v19
  v_exp_f32 v202, v202
  v_exp_f32 v203, v203
  s_waitcnt lgkmcnt(0)
  v_mfma_f32_32x32x16_bf16 v[156:171], v[220:223], v[60:63], 4.0
  ds_read_b64_tr_b16 v[236:237], v18 offset:24576
  v_exp_f32 v204, v204
  v_exp_f32 v205, v205
  v_exp_f32 v206, v206
  v_mfma_f32_32x32x16_bf16 v[156:171], v[224:227], v[64:67], v[156:171]
  ds_read_b64_tr_b16 v[238:239], v18 offset:24832
  v_exp_f32 v207, v207
  v_exp_f32 v208, v208
  v_exp_f32 v209, v209
  v_smfmac_f32_32x32x32_bf16 v[108:123], v[248:251], v[196:203], v19
  ds_read_b64_tr_b16 v[240:241], v18 offset:25600
  v_exp_f32 v210, v210
  v_exp_f32 v211, v211
  v_exp_f32 v212, v212
  v_smfmac_f32_16x16x64_bf16 v[148:151], v[24:27], v[196:203], v19
  ds_read_b64_tr_b16 v[242:243], v18 offset:25856
  v_exp_f32 v213, v213
  v_exp_f32 v214, v214
  v_smfmac_f32_32x32x32_bf16 v[124:139], v[244:247], v[204:211], v19
  ds_read_b128 v[228:231], v16 offset:10240
  v_exp_f32 v215, v215
  v_exp_f32 v216, v216
  v_exp_f32 v217, v217
  v_smfmac_f32_16x16x64_bf16 v[152:155], v[24:27], v[204:211], v19
  ds_read_b128 v[232:235], v17 offset:10240
  v_exp_f32 v218, v218
  v_exp_f32 v219, v219
  v_mfma_f32_32x32x16_bf16 v[172:187], v[220:223], v[68:71], 4.0
  v_exp_f32 v156, v156
  v_exp_f32 v157, v157
  v_exp_f32 v158, v158
  v_mfma_f32_32x32x16_bf16 v[172:187], v[224:227], v[72:75], v[172:187]
  v_exp_f32 v159, v159
  v_exp_f32 v160, v160
  v_exp_f32 v161, v161
  v_smfmac_f32_32x32x32_bf16 v[124:139], v[248:251], v[212:219], v19
  v_exp_f32 v162, v162
  v_exp_f32 v163, v163
  v_exp_f32 v164, v164
  v_smfmac_f32_16x16x64_bf16 v[152:155], v[24:27], v[212:219], v19
  v_exp_f32 v165, v165
  v_exp_f32 v166, v166
  s_waitcnt lgkmcnt(2)
  v_smfmac_f32_32x32x32_bf16 v[108:123], v[236:239], v[156:163], v19
  v_exp_f32 v167, v167
  v_exp_f32 v168, v168
  v_exp_f32 v169, v169
  v_smfmac_f32_16x16x64_bf16 v[148:151], v[24:27], v[156:163], v19
  v_exp_f32 v170, v170
  v_exp_f32 v171, v171
  s_waitcnt lgkmcnt(0)
  v_mfma_f32_32x32x16_bf16 v[188:203], v[228:231], v[60:63], 4.0
  ds_read_b64_tr_b16 v[244:245], v18 offset:26624
  v_exp_f32 v172, v172
  v_exp_f32 v173, v173
  v_exp_f32 v174, v174
  v_mfma_f32_32x32x16_bf16 v[188:203], v[232:235], v[64:67], v[188:203]
  ds_read_b64_tr_b16 v[246:247], v18 offset:26880
  v_exp_f32 v175, v175
  v_exp_f32 v176, v176
  v_exp_f32 v177, v177
  v_smfmac_f32_32x32x32_bf16 v[108:123], v[240:243], v[164:171], v19
  ds_read_b64_tr_b16 v[248:249], v18 offset:27648
  v_exp_f32 v178, v178
  v_exp_f32 v179, v179
  v_exp_f32 v180, v180
  v_smfmac_f32_16x16x64_bf16 v[148:151], v[24:27], v[164:171], v19
  ds_read_b64_tr_b16 v[250:251], v18 offset:27904
  v_exp_f32 v181, v181
  v_exp_f32 v182, v182
  v_smfmac_f32_32x32x32_bf16 v[124:139], v[236:239], v[172:179], v19
  ds_read_b128 v[220:223], v16 offset:12288
  v_exp_f32 v183, v183
  v_exp_f32 v184, v184
  v_exp_f32 v185, v185
  v_smfmac_f32_16x16x64_bf16 v[152:155], v[24:27], v[172:179], v19
  ds_read_b128 v[224:227], v17 offset:12288
  v_exp_f32 v186, v186
  v_exp_f32 v187, v187
  v_mfma_f32_32x32x16_bf16 v[204:219], v[228:231], v[68:71], 4.0
  v_exp_f32 v188, v188
  v_exp_f32 v189, v189
  v_exp_f32 v190, v190
  v_mfma_f32_32x32x16_bf16 v[204:219], v[232:235], v[72:75], v[204:219]
  v_exp_f32 v191, v191
  v_exp_f32 v192, v192
  v_exp_f32 v193, v193
  v_smfmac_f32_32x32x32_bf16 v[124:139], v[240:243], v[180:187], v19
  v_exp_f32 v194, v194
  v_exp_f32 v195, v195
  v_exp_f32 v196, v196
  v_smfmac_f32_16x16x64_bf16 v[152:155], v[24:27], v[180:187], v19
  v_exp_f32 v197, v197
  v_exp_f32 v198, v198
  s_waitcnt lgkmcnt(2)
  v_smfmac_f32_32x32x32_bf16 v[108:123], v[244:247], v[188:195], v19
  v_exp_f32 v199, v199
  v_exp_f32 v200, v200
  v_exp_f32 v201, v201
  v_smfmac_f32_16x16x64_bf16 v[148:151], v[24:27], v[188:195], v19
  v_exp_f32 v202, v202
  v_exp_f32 v203, v203
  s_waitcnt lgkmcnt(0)
  v_mfma_f32_32x32x16_bf16 v[156:171], v[220:223], v[60:63], 4.0
  ds_read_b64_tr_b16 v[236:237], v18 offset:28672
  v_exp_f32 v204, v204
  v_exp_f32 v205, v205
  v_exp_f32 v206, v206
  v_mfma_f32_32x32x16_bf16 v[156:171], v[224:227], v[64:67], v[156:171]
  ds_read_b64_tr_b16 v[238:239], v18 offset:28928
  v_exp_f32 v207, v207
  v_exp_f32 v208, v208
  v_exp_f32 v209, v209
  v_smfmac_f32_32x32x32_bf16 v[108:123], v[248:251], v[196:203], v19
  ds_read_b64_tr_b16 v[240:241], v18 offset:29696
  v_exp_f32 v210, v210
  v_exp_f32 v211, v211
  v_exp_f32 v212, v212
  v_smfmac_f32_16x16x64_bf16 v[148:151], v[24:27], v[196:203], v19
  ds_read_b64_tr_b16 v[242:243], v18 offset:29952
  v_exp_f32 v213, v213
  v_exp_f32 v214, v214
  v_smfmac_f32_32x32x32_bf16 v[124:139], v[244:247], v[204:211], v19
  ds_read_b128 v[228:231], v16 offset:14336
  v_exp_f32 v215, v215
  v_exp_f32 v216, v216
  v_exp_f32 v217, v217
  v_smfmac_f32_16x16x64_bf16 v[152:155], v[24:27], v[204:211], v19
  ds_read_b128 v[232:235], v17 offset:14336
  v_exp_f32 v218, v218
  v_exp_f32 v219, v219
  v_mfma_f32_32x32x16_bf16 v[172:187], v[220:223], v[68:71], 4.0
  v_exp_f32 v156, v156
  v_exp_f32 v157, v157
  v_exp_f32 v158, v158
  v_mfma_f32_32x32x16_bf16 v[172:187], v[224:227], v[72:75], v[172:187]
  v_exp_f32 v159, v159
  v_exp_f32 v160, v160
  v_exp_f32 v161, v161
  v_smfmac_f32_32x32x32_bf16 v[124:139], v[248:251], v[212:219], v19
  v_exp_f32 v162, v162
  v_exp_f32 v163, v163
  v_exp_f32 v164, v164
  v_smfmac_f32_16x16x64_bf16 v[152:155], v[24:27], v[212:219], v19
  v_exp_f32 v165, v165
  v_exp_f32 v166, v166
  s_waitcnt lgkmcnt(2)
  v_smfmac_f32_32x32x32_bf16 v[108:123], v[236:239], v[156:163], v19
  v_exp_f32 v167, v167
  v_exp_f32 v168, v168
  v_exp_f32 v169, v169
  v_smfmac_f32_16x16x64_bf16 v[148:151], v[24:27], v[156:163], v19
  v_exp_f32 v170, v170
  v_exp_f32 v171, v171
  s_barrier
  s_add_u32 s34, s34, 32768
  s_and_b32 s34, s34, 0x1ffff
  v_add_u32 v16, s34, v13
  v_add_u32 v17, s34, v14
  s_waitcnt lgkmcnt(0)
  v_mfma_f32_32x32x16_bf16 v[188:203], v[228:231], v[60:63], 4.0
  ds_read_b64_tr_b16 v[244:245], v18 offset:30720
  v_exp_f32 v172, v172
  v_exp_f32 v173, v173
  v_exp_f32 v174, v174
  v_mfma_f32_32x32x16_bf16 v[188:203], v[232:235], v[64:67], v[188:203]
  ds_read_b64_tr_b16 v[246:247], v18 offset:30976
  v_exp_f32 v175, v175
  v_exp_f32 v176, v176
  v_exp_f32 v177, v177
  v_smfmac_f32_32x32x32_bf16 v[108:123], v[240:243], v[164:171], v19
  ds_read_b64_tr_b16 v[248:249], v18 offset:31744
  v_exp_f32 v178, v178
  v_exp_f32 v179, v179
  v_exp_f32 v180, v180
  v_smfmac_f32_16x16x64_bf16 v[148:151], v[24:27], v[164:171], v19
  ds_read_b64_tr_b16 v[250:251], v18 offset:32000
  v_exp_f32 v181, v181
  v_exp_f32 v182, v182
  v_smfmac_f32_32x32x32_bf16 v[124:139], v[236:239], v[172:179], v19
  ds_read_b128 v[220:223], v16 offset:0
  v_exp_f32 v183, v183
  v_exp_f32 v184, v184
  v_exp_f32 v185, v185
  v_smfmac_f32_16x16x64_bf16 v[152:155], v[24:27], v[172:179], v19
  ds_read_b128 v[224:227], v17 offset:0
  v_exp_f32 v186, v186
  v_exp_f32 v187, v187
  v_mfma_f32_32x32x16_bf16 v[204:219], v[228:231], v[68:71], 4.0
  v_exp_f32 v188, v188
  v_exp_f32 v189, v189
  v_exp_f32 v190, v190
  v_mfma_f32_32x32x16_bf16 v[204:219], v[232:235], v[72:75], v[204:219]
  v_exp_f32 v191, v191
  v_exp_f32 v192, v192
  v_exp_f32 v193, v193
  v_smfmac_f32_32x32x32_bf16 v[124:139], v[240:243], v[180:187], v19
  v_exp_f32 v194, v194
  v_exp_f32 v195, v195
  v_exp_f32 v196, v196
  v_smfmac_f32_16x16x64_bf16 v[152:155], v[24:27], v[180:187], v19
  v_exp_f32 v197, v197
  v_exp_f32 v198, v198
  s_waitcnt lgkmcnt(2)
  v_smfmac_f32_32x32x32_bf16 v[108:123], v[244:247], v[188:195], v19
  v_exp_f32 v199, v199
  v_exp_f32 v200, v200
  v_exp_f32 v201, v201
  v_smfmac_f32_16x16x64_bf16 v[148:151], v[24:27], v[188:195], v19
  v_exp_f32 v202, v202
  v_exp_f32 v203, v203
  v_add_u32 v18, s34, v15
  s_waitcnt lgkmcnt(0)
  v_mfma_f32_32x32x16_bf16 v[156:171], v[220:223], v[44:47], 4.0
  ds_read_b64_tr_b16 v[236:237], v18 offset:16384
  v_exp_f32 v204, v204
  v_exp_f32 v205, v205
  v_exp_f32 v206, v206
  v_mfma_f32_32x32x16_bf16 v[156:171], v[224:227], v[48:51], v[156:171]
  ds_read_b64_tr_b16 v[238:239], v18 offset:16640
  v_exp_f32 v207, v207
  v_exp_f32 v208, v208
  v_exp_f32 v209, v209
  v_smfmac_f32_32x32x32_bf16 v[108:123], v[248:251], v[196:203], v19
  ds_read_b64_tr_b16 v[240:241], v18 offset:17408
  v_exp_f32 v210, v210
  v_exp_f32 v211, v211
  v_exp_f32 v212, v212
  v_smfmac_f32_16x16x64_bf16 v[148:151], v[24:27], v[196:203], v19
  ds_read_b64_tr_b16 v[242:243], v18 offset:17664
  v_exp_f32 v213, v213
  v_exp_f32 v214, v214
  v_smfmac_f32_32x32x32_bf16 v[124:139], v[244:247], v[204:211], v19
  ds_read_b128 v[228:231], v16 offset:2048
  v_exp_f32 v215, v215
  v_exp_f32 v216, v216
  v_exp_f32 v217, v217
  v_smfmac_f32_16x16x64_bf16 v[152:155], v[24:27], v[204:211], v19
  ds_read_b128 v[232:235], v17 offset:2048
  v_exp_f32 v218, v218
  v_exp_f32 v219, v219
.p2align 6
L_loop:
  v_mfma_f32_32x32x16_bf16 v[172:187], v[220:223], v[52:55], 4.0
  v_exp_f32 v156, v156
  v_exp_f32 v157, v157
  v_exp_f32 v158, v158
  v_mfma_f32_32x32x16_bf16 v[172:187], v[224:227], v[56:59], v[172:187]
  v_exp_f32 v159, v159
  v_exp_f32 v160, v160
  v_exp_f32 v161, v161
  v_smfmac_f32_32x32x32_bf16 v[124:139], v[248:251], v[212:219], v19
  v_exp_f32 v162, v162
  v_exp_f32 v163, v163
  v_exp_f32 v164, v164
  v_smfmac_f32_16x16x64_bf16 v[152:155], v[24:27], v[212:219], v19
  v_exp_f32 v165, v165
  v_exp_f32 v166, v166
  s_waitcnt lgkmcnt(2)
  v_smfmac_f32_32x32x32_bf16 v[76:91], v[236:239], v[156:163], v19
  v_exp_f32 v167, v167
  v_exp_f32 v168, v168
  v_exp_f32 v169, v169
  v_smfmac_f32_16x16x64_bf16 v[140:143], v[24:27], v[156:163], v19
  v_exp_f32 v170, v170
  v_exp_f32 v171, v171
  v_mfma_f32_32x32x16_bf16 v[188:203], v[220:223], v[60:63], 4.0
  ds_read_b64_tr_b16 v[244:245], v18 offset:18432
  v_exp_f32 v172, v172
  v_exp_f32 v173, v173
  v_exp_f32 v174, v174
  v_mfma_f32_32x32x16_bf16 v[188:203], v[224:227], v[64:67], v[188:203]
  ds_read_b64_tr_b16 v[246:247], v18 offset:18688
  v_exp_f32 v175, v175
  v_exp_f32 v176, v176
  v_exp_f32 v177, v177
  v_smfmac_f32_32x32x32_bf16 v[76:91], v[240:243], v[164:171], v19
  ds_read_b64_tr_b16 v[248:249], v18 offset:19456
  v_exp_f32 v178, v178
  v_exp_f32 v179, v179
  v_exp_f32 v180, v180
  v_smfmac_f32_16x16x64_bf16 v[140:143], v[24:27], v[164:171], v19
  ds_read_b64_tr_b16 v[250:251], v18 offset:19712
  v_exp_f32 v181, v181
  v_exp_f32 v182, v182
  v_smfmac_f32_32x32x32_bf16 v[92:107], v[236:239], v[172:179], v19
  v_exp_f32 v183, v183
  v_exp_f32 v184, v184
  v_exp_f32 v185, v185
  v_smfmac_f32_16x16x64_bf16 v[144:147], v[24:27], v[172:179], v19
  v_exp_f32 v186, v186
  v_exp_f32 v187, v187
  v_mfma_f32_32x32x16_bf16 v[204:219], v[220:223], v[68:71], 4.0
  v_exp_f32 v188, v188
  v_exp_f32 v189, v189
  v_exp_f32 v190, v190
  v_mfma_f32_32x32x16_bf16 v[204:219], v[224:227], v[72:75], v[204:219]
  v_exp_f32 v191, v191
  v_exp_f32 v192, v192
  v_exp_f32 v193, v193
  v_smfmac_f32_32x32x32_bf16 v[92:107], v[240:243], v[180:187], v19
  v_exp_f32 v194, v194
  v_exp_f32 v195, v195
  v_exp_f32 v196, v196
  v_smfmac_f32_16x16x64_bf16 v[144:147], v[24:27], v[180:187], v19
  v_exp_f32 v197, v197
  v_exp_f32 v198, v198
  v_smfmac_f32_32x32x32_bf16 v[108:123], v[236:239], v[188:195], v19
  v_exp_f32 v199, v199
  v_exp_f32 v200, v200
  v_exp_f32 v201, v201
  v_smfmac_f32_16x16x64_bf16 v[148:151], v[24:27], v[188:195], v19
  v_exp_f32 v202, v202
  v_exp_f32 v203, v203
  s_waitcnt lgkmcnt(0)
  v_mfma_f32_32x32x16_bf16 v[156:171], v[228:231], v[44:47], 4.0
  v_exp_f32 v204, v204
  v_exp_f32 v205, v205
  v_exp_f32 v206, v206
  v_mfma_f32_32x32x16_bf16 v[156:171], v[232:235], v[48:51], v[156:171]
  v_exp_f32 v207, v207
  v_exp_f32 v208, v208
  v_exp_f32 v209, v209
  v_smfmac_f32_32x32x32_bf16 v[108:123], v[240:243], v[196:203], v19
  v_exp_f32 v210, v210
  v_exp_f32 v211, v211
  v_exp_f32 v212, v212
  v_smfmac_f32_16x16x64_bf16 v[148:151], v[24:27], v[196:203], v19
  v_exp_f32 v213, v213
  v_exp_f32 v214, v214
  v_smfmac_f32_32x32x32_bf16 v[124:139], v[236:239], v[204:211], v19
  ds_read_b128 v[220:223], v16 offset:4096
  v_exp_f32 v215, v215
  v_exp_f32 v216, v216
  v_exp_f32 v217, v217
  v_smfmac_f32_16x16x64_bf16 v[152:155], v[24:27], v[204:211], v19
  ds_read_b128 v[224:227], v17 offset:4096
  v_exp_f32 v218, v218
  v_exp_f32 v219, v219
  v_mfma_f32_32x32x16_bf16 v[172:187], v[228:231], v[52:55], 4.0
  v_exp_f32 v156, v156
  v_exp_f32 v157, v157
  v_exp_f32 v158, v158
  v_mfma_f32_32x32x16_bf16 v[172:187], v[232:235], v[56:59], v[172:187]
  v_exp_f32 v159, v159
  v_exp_f32 v160, v160
  v_exp_f32 v161, v161
  v_smfmac_f32_32x32x32_bf16 v[124:139], v[240:243], v[212:219], v19
  v_exp_f32 v162, v162
  v_exp_f32 v163, v163
  v_exp_f32 v164, v164
  v_smfmac_f32_16x16x64_bf16 v[152:155], v[24:27], v[212:219], v19
  v_exp_f32 v165, v165
  v_exp_f32 v166, v166
  v_smfmac_f32_32x32x32_bf16 v[76:91], v[244:247], v[156:163], v19
  v_exp_f32 v167, v167
  v_exp_f32 v168, v168
  v_exp_f32 v169, v169
  v_smfmac_f32_16x16x64_bf16 v[140:143], v[24:27], v[156:163], v19
  v_exp_f32 v170, v170
  v_exp_f32 v171, v171
  v_mfma_f32_32x32x16_bf16 v[188:203], v[228:231], v[60:63], 4.0
  ds_read_b64_tr_b16 v[236:237], v18 offset:20480
  v_exp_f32 v172, v172
  v_exp_f32 v173, v173
  v_exp_f32 v174, v174
  v_mfma_f32_32x32x16_bf16 v[188:203], v[232:235], v[64:67], v[188:203]
  ds_read_b64_tr_b16 v[238:239], v18 offset:20736
  v_exp_f32 v175, v175
  v_exp_f32 v176, v176
  v_exp_f32 v177, v177
  v_smfmac_f32_32x32x32_bf16 v[76:91], v[248:251], v[164:171], v19
  ds_read_b64_tr_b16 v[240:241], v18 offset:21504
  v_exp_f32 v178, v178
  v_exp_f32 v179, v179
  v_exp_f32 v180, v180
  v_smfmac_f32_16x16x64_bf16 v[140:143], v[24:27], v[164:171], v19
  ds_read_b64_tr_b16 v[242:243], v18 offset:21760
  v_exp_f32 v181, v181
  v_exp_f32 v182, v182
  v_smfmac_f32_32x32x32_bf16 v[92:107], v[244:247], v[172:179], v19
  v_exp_f32 v183, v183
  v_exp_f32 v184, v184
  v_exp_f32 v185, v185
  v_smfmac_f32_16x16x64_bf16 v[144:147], v[24:27], v[172:179], v19
  v_exp_f32 v186, v186
  v_exp_f32 v187, v187
  v_mfma_f32_32x32x16_bf16 v[204:219], v[228:231], v[68:71], 4.0
  v_exp_f32 v188, v188
  v_exp_f32 v189, v189
  v_exp_f32 v190, v190
  v_mfma_f32_32x32x16_bf16 v[204:219], v[232:235], v[72:75], v[204:219]
  v_exp_f32 v191, v191
  v_exp_f32 v192, v192
  v_exp_f32 v193, v193
  v_smfmac_f32_32x32x32_bf16 v[92:107], v[248:251], v[180:187], v19
  v_exp_f32 v194, v194
  v_exp_f32 v195, v195
  v_exp_f32 v196, v196
  v_smfmac_f32_16x16x64_bf16 v[144:147], v[24:27], v[180:187], v19
  v_exp_f32 v197, v197
  v_exp_f32 v198, v198
  v_smfmac_f32_32x32x32_bf16 v[108:123], v[244:247], v[188:195], v19
  v_exp_f32 v199, v199
  v_exp_f32 v200, v200
  v_exp_f32 v201, v201
  v_smfmac_f32_16x16x64_bf16 v[148:151], v[24:27], v[188:195], v19
  v_exp_f32 v202, v202
  v_exp_f32 v203, v203
  s_waitcnt lgkmcnt(0)
  v_mfma_f32_32x32x16_bf16 v[156:171], v[220:223], v[44:47], 4.0
  v_exp_f32 v204, v204
  v_exp_f32 v205, v205
  v_exp_f32 v206, v206
  v_mfma_f32_32x32x16_bf16 v[156:171], v[224:227], v[48:51], v[156:171]
  v_exp_f32 v207, v207
  v_exp_f32 v208, v208
  v_exp_f32 v209, v209
  v_smfmac_f32_32x32x32_bf16 v[108:123], v[248:251], v[196:203], v19
  v_exp_f32 v210, v210
  v_exp_f32 v211, v211
  v_exp_f32 v212, v212
  v_smfmac_f32_16x16x64_bf16 v[148:151], v[24:27], v[196:203], v19
  v_exp_f32 v213, v213
  v_exp_f32 v214, v214
  v_smfmac_f32_32x32x32_bf16 v[124:139], v[244:247], v[204:211], v19
  ds_read_b128 v[228:231], v16 offset:6144
  v_exp_f32 v215, v215
  v_exp_f32 v216, v216
  v_exp_f32 v217, v217
  v_smfmac_f32_16x16x64_bf16 v[152:155], v[24:27], v[204:211], v19
  ds_read_b128 v[232:235], v17 offset:6144
  v_exp_f32 v218, v218
  v_exp_f32 v219, v219
  v_mfma_f32_32x32x16_bf16 v[172:187], v[220:223], v[52:55], 4.0
  v_exp_f32 v156, v156
  v_exp_f32 v157, v157
  v_exp_f32 v158, v158
  v_mfma_f32_32x32x16_bf16 v[172:187], v[224:227], v[56:59], v[172:187]
  v_exp_f32 v159, v159
  v_exp_f32 v160, v160
  v_exp_f32 v161, v161
  v_smfmac_f32_32x32x32_bf16 v[124:139], v[248:251], v[212:219], v19
  v_exp_f32 v162, v162
  v_exp_f32 v163, v163
  v_exp_f32 v164, v164
  v_smfmac_f32_16x16x64_bf16 v[152:155], v[24:27], v[212:219], v19
  v_exp_f32 v165, v165
  v_exp_f32 v166, v166
  v_smfmac_f32_32x32x32_bf16 v[76:91], v[236:239], v[156:163], v19
  v_exp_f32 v167, v167
  v_exp_f32 v168, v168
  v_exp_f32 v169, v169
  v_smfmac_f32_16x16x64_bf16 v[140:143], v[24:27], v[156:163], v19
  v_exp_f32 v170, v170
  v_exp_f32 v171, v171
  v_mfma_f32_32x32x16_bf16 v[188:203], v[220:223], v[60:63], 4.0
  ds_read_b64_tr_b16 v[244:245], v18 offset:22528
  v_exp_f32 v172, v172
  v_exp_f32 v173, v173
  v_exp_f32 v174, v174
  v_mfma_f32_32x32x16_bf16 v[188:203], v[224:227], v[64:67], v[188:203]
  ds_read_b64_tr_b16 v[246:247], v18 offset:22784
  v_exp_f32 v175, v175
  v_exp_f32 v176, v176
  v_exp_f32 v177, v177
  v_smfmac_f32_32x32x32_bf16 v[76:91], v[240:243], v[164:171], v19
  ds_read_b64_tr_b16 v[248:249], v18 offset:23552
  v_exp_f32 v178, v178
  v_exp_f32 v179, v179
  v_exp_f32 v180, v180
  v_smfmac_f32_16x16x64_bf16 v[140:143], v[24:27], v[164:171], v19
  ds_read_b64_tr_b16 v[250:251], v18 offset:23808
  v_exp_f32 v181, v181
  v_exp_f32 v182, v182
  v_smfmac_f32_32x32x32_bf16 v[92:107], v[236:239], v[172:179], v19
  v_exp_f32 v183, v183
  v_exp_f32 v184, v184
  v_exp_f32 v185, v185
  v_smfmac_f32_16x16x64_bf16 v[144:147], v[24:27], v[172:179], v19
  v_exp_f32 v186, v186
  v_exp_f32 v187, v187
  v_mfma_f32_32x32x16_bf16 v[204:219], v[220:223], v[68:71], 4.0
  v_exp_f32 v188, v188
  v_exp_f32 v189, v189
  v_exp_f32 v190, v190
  v_mfma_f32_32x32x16_bf16 v[204:219], v[224:227], v[72:75], v[204:219]
  v_exp_f32 v191, v191
  v_exp_f32 v192, v192
  v_exp_f32 v193, v193
  v_smfmac_f32_32x32x32_bf16 v[92:107], v[240:243], v[180:187], v19
  v_exp_f32 v194, v194
  v_exp_f32 v195, v195
  v_exp_f32 v196, v196
  v_smfmac_f32_16x16x64_bf16 v[144:147], v[24:27], v[180:187], v19
  v_exp_f32 v197, v197
  v_exp_f32 v198, v198
  v_smfmac_f32_32x32x32_bf16 v[108:123], v[236:239], v[188:195], v19
  v_exp_f32 v199, v199
  v_exp_f32 v200, v200
  v_exp_f32 v201, v201
  v_smfmac_f32_16x16x64_bf16 v[148:151], v[24:27], v[188:195], v19
  v_exp_f32 v202, v202
  v_exp_f32 v203, v203
  s_waitcnt lgkmcnt(0)
  v_mfma_f32_32x32x16_bf16 v[156:171], v[228:231], v[44:47], 4.0
  v_exp_f32 v204, v204
  v_exp_f32 v205, v205
  v_exp_f32 v206, v206
  v_mfma_f32_32x32x16_bf16 v[156:171], v[232:235], v[48:51], v[156:171]
  v_exp_f32 v207, v207
  v_exp_f32 v208, v208
  v_exp_f32 v209, v209
  v_smfmac_f32_32x32x32_bf16 v[108:123], v[240:243], v[196:203], v19
  v_exp_f32 v210, v210
  v_exp_f32 v211, v211
  v_exp_f32 v212, v212
  v_smfmac_f32_16x16x64_bf16 v[148:151], v[24:27], v[196:203], v19
  v_exp_f32 v213, v213
  v_exp_f32 v214, v214
  v_smfmac_f32_32x32x32_bf16 v[124:139], v[236:239], v[204:211], v19
  ds_read_b128 v[220:223], v16 offset:8192
  v_exp_f32 v215, v215
  v_exp_f32 v216, v216
  v_exp_f32 v217, v217
  v_smfmac_f32_16x16x64_bf16 v[152:155], v[24:27], v[204:211], v19
  ds_read_b128 v[224:227], v17 offset:8192
  v_exp_f32 v218, v218
  v_exp_f32 v219, v219
  v_mfma_f32_32x32x16_bf16 v[172:187], v[228:231], v[52:55], 4.0
  v_exp_f32 v156, v156
  v_exp_f32 v157, v157
  v_exp_f32 v158, v158
  v_mfma_f32_32x32x16_bf16 v[172:187], v[232:235], v[56:59], v[172:187]
  v_exp_f32 v159, v159
  v_exp_f32 v160, v160
  v_exp_f32 v161, v161
  v_smfmac_f32_32x32x32_bf16 v[124:139], v[240:243], v[212:219], v19
  v_exp_f32 v162, v162
  v_exp_f32 v163, v163
  v_exp_f32 v164, v164
  v_smfmac_f32_16x16x64_bf16 v[152:155], v[24:27], v[212:219], v19
  v_exp_f32 v165, v165
  v_exp_f32 v166, v166
  v_smfmac_f32_32x32x32_bf16 v[76:91], v[244:247], v[156:163], v19
  v_exp_f32 v167, v167
  v_exp_f32 v168, v168
  v_exp_f32 v169, v169
  v_smfmac_f32_16x16x64_bf16 v[140:143], v[24:27], v[156:163], v19
  v_exp_f32 v170, v170
  v_exp_f32 v171, v171
  v_mfma_f32_32x32x16_bf16 v[188:203], v[228:231], v[60:63], 4.0
  ds_read_b64_tr_b16 v[236:237], v18 offset:24576
  v_exp_f32 v172, v172
  v_exp_f32 v173, v173
  v_exp_f32 v174, v174
  v_mfma_f32_32x32x16_bf16 v[188:203], v[232:235], v[64:67], v[188:203]
  ds_read_b64_tr_b16 v[238:239], v18 offset:24832
  v_exp_f32 v175, v175
  v_exp_f32 v176, v176
  v_exp_f32 v177, v177
  v_smfmac_f32_32x32x32_bf16 v[76:91], v[248:251], v[164:171], v19
  ds_read_b64_tr_b16 v[240:241], v18 offset:25600
  v_exp_f32 v178, v178
  v_exp_f32 v179, v179
  v_exp_f32 v180, v180
  v_smfmac_f32_16x16x64_bf16 v[140:143], v[24:27], v[164:171], v19
  ds_read_b64_tr_b16 v[242:243], v18 offset:25856
  v_exp_f32 v181, v181
  v_exp_f32 v182, v182
  v_smfmac_f32_32x32x32_bf16 v[92:107], v[244:247], v[172:179], v19
  v_exp_f32 v183, v183
  v_exp_f32 v184, v184
  v_exp_f32 v185, v185
  v_smfmac_f32_16x16x64_bf16 v[144:147], v[24:27], v[172:179], v19
  v_exp_f32 v186, v186
  v_exp_f32 v187, v187
  v_mfma_f32_32x32x16_bf16 v[204:219], v[228:231], v[68:71], 4.0
  v_exp_f32 v188, v188
  v_exp_f32 v189, v189
  v_exp_f32 v190, v190
  v_mfma_f32_32x32x16_bf16 v[204:219], v[232:235], v[72:75], v[204:219]
  v_exp_f32 v191, v191
  v_exp_f32 v192, v192
  v_exp_f32 v193, v193
  v_smfmac_f32_32x32x32_bf16 v[92:107], v[248:251], v[180:187], v19
  v_exp_f32 v194, v194
  v_exp_f32 v195, v195
  v_exp_f32 v196, v196
  v_smfmac_f32_16x16x64_bf16 v[144:147], v[24:27], v[180:187], v19
  v_exp_f32 v197, v197
  v_exp_f32 v198, v198
  v_smfmac_f32_32x32x32_bf16 v[108:123], v[244:247], v[188:195], v19
  v_exp_f32 v199, v199
  v_exp_f32 v200, v200
  v_exp_f32 v201, v201
  v_smfmac_f32_16x16x64_bf16 v[148:151], v[24:27], v[188:195], v19
  v_exp_f32 v202, v202
  v_exp_f32 v203, v203
  s_waitcnt lgkmcnt(0)
  v_mfma_f32_32x32x16_bf16 v[156:171], v[220:223], v[44:47], 4.0
  v_exp_f32 v204, v204
  v_exp_f32 v205, v205
  v_exp_f32 v206, v206
  v_mfma_f32_32x32x16_bf16 v[156:171], v[224:227], v[48:51], v[156:171]
  v_exp_f32 v207, v207
  v_exp_f32 v208, v208
  v_exp_f32 v209, v209
  v_smfmac_f32_32x32x32_bf16 v[108:123], v[248:251], v[196:203], v19
  v_exp_f32 v210, v210
  v_exp_f32 v211, v211
  v_exp_f32 v212, v212
  v_smfmac_f32_16x16x64_bf16 v[148:151], v[24:27], v[196:203], v19
  v_exp_f32 v213, v213
  v_exp_f32 v214, v214
  v_smfmac_f32_32x32x32_bf16 v[124:139], v[244:247], v[204:211], v19
  ds_read_b128 v[228:231], v16 offset:10240
  v_exp_f32 v215, v215
  v_exp_f32 v216, v216
  v_exp_f32 v217, v217
  v_smfmac_f32_16x16x64_bf16 v[152:155], v[24:27], v[204:211], v19
  ds_read_b128 v[232:235], v17 offset:10240
  v_exp_f32 v218, v218
  v_exp_f32 v219, v219
  v_mfma_f32_32x32x16_bf16 v[172:187], v[220:223], v[52:55], 4.0
  v_exp_f32 v156, v156
  v_exp_f32 v157, v157
  v_exp_f32 v158, v158
  v_mfma_f32_32x32x16_bf16 v[172:187], v[224:227], v[56:59], v[172:187]
  v_exp_f32 v159, v159
  v_exp_f32 v160, v160
  v_exp_f32 v161, v161
  v_smfmac_f32_32x32x32_bf16 v[124:139], v[248:251], v[212:219], v19
  v_exp_f32 v162, v162
  v_exp_f32 v163, v163
  v_exp_f32 v164, v164
  v_smfmac_f32_16x16x64_bf16 v[152:155], v[24:27], v[212:219], v19
  v_exp_f32 v165, v165
  v_exp_f32 v166, v166
  v_smfmac_f32_32x32x32_bf16 v[76:91], v[236:239], v[156:163], v19
  v_exp_f32 v167, v167
  v_exp_f32 v168, v168
  v_exp_f32 v169, v169
  v_smfmac_f32_16x16x64_bf16 v[140:143], v[24:27], v[156:163], v19
  v_exp_f32 v170, v170
  v_exp_f32 v171, v171
  v_mfma_f32_32x32x16_bf16 v[188:203], v[220:223], v[60:63], 4.0
  ds_read_b64_tr_b16 v[244:245], v18 offset:26624
  v_exp_f32 v172, v172
  v_exp_f32 v173, v173
  v_exp_f32 v174, v174
  v_mfma_f32_32x32x16_bf16 v[188:203], v[224:227], v[64:67], v[188:203]
  ds_read_b64_tr_b16 v[246:247], v18 offset:26880
  v_exp_f32 v175, v175
  v_exp_f32 v176, v176
  v_exp_f32 v177, v177
  v_smfmac_f32_32x32x32_bf16 v[76:91], v[240:243], v[164:171], v19
  ds_read_b64_tr_b16 v[248:249], v18 offset:27648
  v_exp_f32 v178, v178
  v_exp_f32 v179, v179
  v_exp_f32 v180, v180
  v_smfmac_f32_16x16x64_bf16 v[140:143], v[24:27], v[164:171], v19
  ds_read_b64_tr_b16 v[250:251], v18 offset:27904
  v_exp_f32 v181, v181
  v_exp_f32 v182, v182
  v_smfmac_f32_32x32x32_bf16 v[92:107], v[236:239], v[172:179], v19
  v_exp_f32 v183, v183
  v_exp_f32 v184, v184
  v_exp_f32 v185, v185
  v_smfmac_f32_16x16x64_bf16 v[144:147], v[24:27], v[172:179], v19
  v_exp_f32 v186, v186
  v_exp_f32 v187, v187
  v_mfma_f32_32x32x16_bf16 v[204:219], v[220:223], v[68:71], 4.0
  v_exp_f32 v188, v188
  v_exp_f32 v189, v189
  v_exp_f32 v190, v190
  v_mfma_f32_32x32x16_bf16 v[204:219], v[224:227], v[72:75], v[204:219]
  v_exp_f32 v191, v191
  v_exp_f32 v192, v192
  v_exp_f32 v193, v193
  v_smfmac_f32_32x32x32_bf16 v[92:107], v[240:243], v[180:187], v19
  v_exp_f32 v194, v194
  v_exp_f32 v195, v195
  v_exp_f32 v196, v196
  v_smfmac_f32_16x16x64_bf16 v[144:147], v[24:27], v[180:187], v19
  v_exp_f32 v197, v197
  v_exp_f32 v198, v198
  v_smfmac_f32_32x32x32_bf16 v[108:123], v[236:239], v[188:195], v19
  v_exp_f32 v199, v199
  v_exp_f32 v200, v200
  v_exp_f32 v201, v201
  v_smfmac_f32_16x16x64_bf16 v[148:151], v[24:27], v[188:195], v19
  v_exp_f32 v202, v202
  v_exp_f32 v203, v203
  s_waitcnt lgkmcnt(0)
  v_mfma_f32_32x32x16_bf16 v[156:171], v[228:231], v[44:47], 4.0
  v_exp_f32 v204, v204
  v_exp_f32 v205, v205
  v_exp_f32 v206, v206
  v_mfma_f32_32x32x16_bf16 v[156:171], v[232:235], v[48:51], v[156:171]
  v_exp_f32 v207, v207
  v_exp_f32 v208, v208
  v_exp_f32 v209, v209
  v_smfmac_f32_32x32x32_bf16 v[108:123], v[240:243], v[196:203], v19
  v_exp_f32 v210, v210
  v_exp_f32 v211, v211
  v_exp_f32 v212, v212
  v_smfmac_f32_16x16x64_bf16 v[148:151], v[24:27], v[196:203], v19
  v_exp_f32 v213, v213
  v_exp_f32 v214, v214
  v_smfmac_f32_32x32x32_bf16 v[124:139], v[236:239], v[204:211], v19
  ds_read_b128 v[220:223], v16 offset:12288
  v_exp_f32 v215, v215
  v_exp_f32 v216, v216
  v_exp_f32 v217, v217
  v_smfmac_f32_16x16x64_bf16 v[152:155], v[24:27], v[204:211], v19
  ds_read_b128 v[224:227], v17 offset:12288
  v_exp_f32 v218, v218
  v_exp_f32 v219, v219
  v_mfma_f32_32x32x16_bf16 v[172:187], v[228:231], v[52:55], 4.0
  v_exp_f32 v156, v156
  v_exp_f32 v157, v157
  v_exp_f32 v158, v158
  v_mfma_f32_32x32x16_bf16 v[172:187], v[232:235], v[56:59], v[172:187]
  v_exp_f32 v159, v159
  v_exp_f32 v160, v160
  v_exp_f32 v161, v161
  v_smfmac_f32_32x32x32_bf16 v[124:139], v[240:243], v[212:219], v19
  v_exp_f32 v162, v162
  v_exp_f32 v163, v163
  v_exp_f32 v164, v164
  v_smfmac_f32_16x16x64_bf16 v[152:155], v[24:27], v[212:219], v19
  v_exp_f32 v165, v165
  v_exp_f32 v166, v166
  v_smfmac_f32_32x32x32_bf16 v[76:91], v[244:247], v[156:163], v19
  v_exp_f32 v167, v167
  v_exp_f32 v168, v168
  v_exp_f32 v169, v169
  v_smfmac_f32_16x16x64_bf16 v[140:143], v[24:27], v[156:163], v19
  v_exp_f32 v170, v170
  v_exp_f32 v171, v171
  v_mfma_f32_32x32x16_bf16 v[188:203], v[228:231], v[60:63], 4.0
  ds_read_b64_tr_b16 v[236:237], v18 offset:28672
  v_exp_f32 v172, v172
  v_exp_f32 v173, v173
  v_exp_f32 v174, v174
  v_mfma_f32_32x32x16_bf16 v[188:203], v[232:235], v[64:67], v[188:203]
  ds_read_b64_tr_b16 v[238:239], v18 offset:28928
  v_exp_f32 v175, v175
  v_exp_f32 v176, v176
  v_exp_f32 v177, v177
  v_smfmac_f32_32x32x32_bf16 v[76:91], v[248:251], v[164:171], v19
  ds_read_b64_tr_b16 v[240:241], v18 offset:29696
  v_exp_f32 v178, v178
  v_exp_f32 v179, v179
  v_exp_f32 v180, v180
  v_smfmac_f32_16x16x64_bf16 v[140:143], v[24:27], v[164:171], v19
  ds_read_b64_tr_b16 v[242:243], v18 offset:29952
  v_exp_f32 v181, v181
  v_exp_f32 v182, v182
  v_smfmac_f32_32x32x32_bf16 v[92:107], v[244:247], v[172:179], v19
  v_exp_f32 v183, v183
  v_exp_f32 v184, v184
  v_exp_f32 v185, v185
  v_smfmac_f32_16x16x64_bf16 v[144:147], v[24:27], v[172:179], v19
  v_exp_f32 v186, v186
  v_exp_f32 v187, v187
  v_mfma_f32_32x32x16_bf16 v[204:219], v[228:231], v[68:71], 4.0
  v_exp_f32 v188, v188
  v_exp_f32 v189, v189
  v_exp_f32 v190, v190
  v_mfma_f32_32x32x16_bf16 v[204:219], v[232:235], v[72:75], v[204:219]
  v_exp_f32 v191, v191
  v_exp_f32 v192, v192
  v_exp_f32 v193, v193
  v_smfmac_f32_32x32x32_bf16 v[92:107], v[248:251], v[180:187], v19
  v_exp_f32 v194, v194
  v_exp_f32 v195, v195
  v_exp_f32 v196, v196
  v_smfmac_f32_16x16x64_bf16 v[144:147], v[24:27], v[180:187], v19
  v_exp_f32 v197, v197
  v_exp_f32 v198, v198
  v_smfmac_f32_32x32x32_bf16 v[108:123], v[244:247], v[188:195], v19
  v_exp_f32 v199, v199
  v_exp_f32 v200, v200
  v_exp_f32 v201, v201
  v_smfmac_f32_16x16x64_bf16 v[148:151], v[24:27], v[188:195], v19
  v_exp_f32 v202, v202
  v_exp_f32 v203, v203
  s_waitcnt lgkmcnt(0)
  v_mfma_f32_32x32x16_bf16 v[156:171], v[220:223], v[44:47], 4.0
  v_exp_f32 v204, v204
  v_exp_f32 v205, v205
  v_exp_f32 v206, v206
  v_mfma_f32_32x32x16_bf16 v[156:171], v[224:227], v[48:51], v[156:171]
  v_exp_f32 v207, v207
  v_exp_f32 v208, v208
  v_exp_f32 v209, v209
  v_smfmac_f32_32x32x32_bf16 v[108:123], v[248:251], v[196:203], v19
  v_exp_f32 v210, v210
  v_exp_f32 v211, v211
  v_exp_f32 v212, v212
  v_smfmac_f32_16x16x64_bf16 v[148:151], v[24:27], v[196:203], v19
  v_exp_f32 v213, v213
  v_exp_f32 v214, v214
  v_smfmac_f32_32x32x32_bf16 v[124:139], v[244:247], v[204:211], v19
  ds_read_b128 v[228:231], v16 offset:14336
  v_exp_f32 v215, v215
  v_exp_f32 v216, v216
  v_exp_f32 v217, v217
  v_smfmac_f32_16x16x64_bf16 v[152:155], v[24:27], v[204:211], v19
  ds_read_b128 v[232:235], v17 offset:14336
  v_exp_f32 v218, v218
  v_exp_f32 v219, v219
  v_mfma_f32_32x32x16_bf16 v[172:187], v[220:223], v[52:55], 4.0
  v_exp_f32 v156, v156
  v_exp_f32 v157, v157
  v_exp_f32 v158, v158
  v_mfma_f32_32x32x16_bf16 v[172:187], v[224:227], v[56:59], v[172:187]
  v_exp_f32 v159, v159
  v_exp_f32 v160, v160
  v_exp_f32 v161, v161
  v_smfmac_f32_32x32x32_bf16 v[124:139], v[248:251], v[212:219], v19
  v_exp_f32 v162, v162
  v_exp_f32 v163, v163
  v_exp_f32 v164, v164
  v_smfmac_f32_16x16x64_bf16 v[152:155], v[24:27], v[212:219], v19
  v_exp_f32 v165, v165
  v_exp_f32 v166, v166
  v_smfmac_f32_32x32x32_bf16 v[76:91], v[236:239], v[156:163], v19
  v_exp_f32 v167, v167
  v_exp_f32 v168, v168
  v_exp_f32 v169, v169
  v_smfmac_f32_16x16x64_bf16 v[140:143], v[24:27], v[156:163], v19
  v_exp_f32 v170, v170
  v_exp_f32 v171, v171
  v_mfma_f32_32x32x16_bf16 v[188:203], v[220:223], v[60:63], 4.0
  ds_read_b64_tr_b16 v[244:245], v18 offset:30720
  v_exp_f32 v172, v172
  v_exp_f32 v173, v173
  v_exp_f32 v174, v174
  v_mfma_f32_32x32x16_bf16 v[188:203], v[224:227], v[64:67], v[188:203]
  ds_read_b64_tr_b16 v[246:247], v18 offset:30976
  v_exp_f32 v175, v175
  v_exp_f32 v176, v176
  v_exp_f32 v177, v177
  v_smfmac_f32_32x32x32_bf16 v[76:91], v[240:243], v[164:171], v19
  ds_read_b64_tr_b16 v[248:249], v18 offset:31744
  v_exp_f32 v178, v178
  v_exp_f32 v179, v179
  v_exp_f32 v180, v180
  v_smfmac_f32_16x16x64_bf16 v[140:143], v[24:27], v[164:171], v19
  ds_read_b64_tr_b16 v[250:251], v18 offset:32000
  v_exp_f32 v181, v181
  v_exp_f32 v182, v182
  v_smfmac_f32_32x32x32_bf16 v[92:107], v[236:239], v[172:179], v19
  v_exp_f32 v183, v183
  v_exp_f32 v184, v184
  v_exp_f32 v185, v185
  v_smfmac_f32_16x16x64_bf16 v[144:147], v[24:27], v[172:179], v19
  v_exp_f32 v186, v186
  v_exp_f32 v187, v187
  v_mfma_f32_32x32x16_bf16 v[204:219], v[220:223], v[68:71], 4.0
  v_exp_f32 v188, v188
  v_exp_f32 v189, v189
  v_exp_f32 v190, v190
  v_mfma_f32_32x32x16_bf16 v[204:219], v[224:227], v[72:75], v[204:219]
  v_exp_f32 v191, v191
  v_exp_f32 v192, v192
  v_exp_f32 v193, v193
  v_smfmac_f32_32x32x32_bf16 v[92:107], v[240:243], v[180:187], v19
  v_exp_f32 v194, v194
  v_exp_f32 v195, v195
  v_exp_f32 v196, v196
  v_smfmac_f32_16x16x64_bf16 v[144:147], v[24:27], v[180:187], v19
  v_exp_f32 v197, v197
  v_exp_f32 v198, v198
  v_smfmac_f32_32x32x32_bf16 v[108:123], v[236:239], v[188:195], v19
  v_exp_f32 v199, v199
  v_exp_f32 v200, v200
  v_exp_f32 v201, v201
  v_smfmac_f32_16x16x64_bf16 v[148:151], v[24:27], v[188:195], v19
  v_exp_f32 v202, v202
  v_exp_f32 v203, v203
  s_barrier
  s_add_u32 s34, s34, 32768
  s_and_b32 s34, s34, 0x1ffff
  v_add_u32 v16, s34, v13
  v_add_u32 v17, s34, v14
  s_waitcnt lgkmcnt(0)
  v_mfma_f32_32x32x16_bf16 v[156:171], v[228:231], v[44:47], 4.0
  v_exp_f32 v204, v204
  v_exp_f32 v205, v205
  v_exp_f32 v206, v206
  v_mfma_f32_32x32x16_bf16 v[156:171], v[232:235], v[48:51], v[156:171]
  v_exp_f32 v207, v207
  v_exp_f32 v208, v208
  v_exp_f32 v209, v209
  v_smfmac_f32_32x32x32_bf16 v[108:123], v[240:243], v[196:203], v19
  v_exp_f32 v210, v210
  v_exp_f32 v211, v211
  v_exp_f32 v212, v212
  v_smfmac_f32_16x16x64_bf16 v[148:151], v[24:27], v[196:203], v19
  v_exp_f32 v213, v213
  v_exp_f32 v214, v214
  v_smfmac_f32_32x32x32_bf16 v[124:139], v[236:239], v[204:211], v19
  ds_read_b128 v[220:223], v16 offset:0
  v_exp_f32 v215, v215
  v_exp_f32 v216, v216
  v_exp_f32 v217, v217
  v_smfmac_f32_16x16x64_bf16 v[152:155], v[24:27], v[204:211], v19
  ds_read_b128 v[224:227], v17 offset:0
  v_exp_f32 v218, v218
  v_exp_f32 v219, v219
  v_mfma_f32_32x32x16_bf16 v[172:187], v[228:231], v[52:55], 4.0
  v_exp_f32 v156, v156
  v_exp_f32 v157, v157
  v_exp_f32 v158, v158
  v_mfma_f32_32x32x16_bf16 v[172:187], v[232:235], v[56:59], v[172:187]
  v_exp_f32 v159, v159
  v_exp_f32 v160, v160
  v_exp_f32 v161, v161
  v_smfmac_f32_32x32x32_bf16 v[124:139], v[240:243], v[212:219], v19
  v_exp_f32 v162, v162
  v_exp_f32 v163, v163
  v_exp_f32 v164, v164
  v_smfmac_f32_16x16x64_bf16 v[152:155], v[24:27], v[212:219], v19
  v_exp_f32 v165, v165
  v_exp_f32 v166, v166
  v_smfmac_f32_32x32x32_bf16 v[76:91], v[244:247], v[156:163], v19
  v_exp_f32 v167, v167
  v_exp_f32 v168, v168
  v_exp_f32 v169, v169
  v_smfmac_f32_16x16x64_bf16 v[140:143], v[24:27], v[156:163], v19
  v_exp_f32 v170, v170
  v_exp_f32 v171, v171
  v_add_u32 v18, s34, v15
  v_mfma_f32_32x32x16_bf16 v[188:203], v[228:231], v[60:63], 4.0
  ds_read_b64_tr_b16 v[236:237], v18 offset:16384
  v_exp_f32 v172, v172
  v_exp_f32 v173, v173
  v_exp_f32 v174, v174
  v_mfma_f32_32x32x16_bf16 v[188:203], v[232:235], v[64:67], v[188:203]
  ds_read_b64_tr_b16 v[238:239], v18 offset:16640
  v_exp_f32 v175, v175
  v_exp_f32 v176, v176
  v_exp_f32 v177, v177
  v_smfmac_f32_32x32x32_bf16 v[76:91], v[248:251], v[164:171], v19
  ds_read_b64_tr_b16 v[240:241], v18 offset:17408
  v_exp_f32 v178, v178
  v_exp_f32 v179, v179
  v_exp_f32 v180, v180
  v_smfmac_f32_16x16x64_bf16 v[140:143], v[24:27], v[164:171], v19
  ds_read_b64_tr_b16 v[242:243], v18 offset:17664
  v_exp_f32 v181, v181
  v_exp_f32 v182, v182
  v_smfmac_f32_32x32x32_bf16 v[92:107], v[244:247], v[172:179], v19
  v_exp_f32 v183, v183
  v_exp_f32 v184, v184
  v_exp_f32 v185, v185
  v_smfmac_f32_16x16x64_bf16 v[144:147], v[24:27], v[172:179], v19
  v_exp_f32 v186, v186
  v_exp_f32 v187, v187
  v_mfma_f32_32x32x16_bf16 v[204:219], v[228:231], v[68:71], 4.0
  v_exp_f32 v188, v188
  v_exp_f32 v189, v189
  v_exp_f32 v190, v190
  v_mfma_f32_32x32x16_bf16 v[204:219], v[232:235], v[72:75], v[204:219]
  v_exp_f32 v191, v191
  v_exp_f32 v192, v192
  v_exp_f32 v193, v193
  v_smfmac_f32_32x32x32_bf16 v[92:107], v[248:251], v[180:187], v19
  v_exp_f32 v194, v194
  v_exp_f32 v195, v195
  v_exp_f32 v196, v196
  v_smfmac_f32_16x16x64_bf16 v[144:147], v[24:27], v[180:187], v19
  v_exp_f32 v197, v197
  v_exp_f32 v198, v198
  v_smfmac_f32_32x32x32_bf16 v[108:123], v[244:247], v[188:195], v19
  v_exp_f32 v199, v199
  v_exp_f32 v200, v200
  v_exp_f32 v201, v201
  v_smfmac_f32_16x16x64_bf16 v[148:151], v[24:27], v[188:195], v19
  v_exp_f32 v202, v202
  v_exp_f32 v203, v203
  s_waitcnt lgkmcnt(0)
  v_mfma_f32_32x32x16_bf16 v[156:171], v[220:223], v[44:47], 4.0
  v_exp_f32 v204, v204
  v_exp_f32 v205, v205
  v_exp_f32 v206, v206
  v_mfma_f32_32x32x16_bf16 v[156:171], v[224:227], v[48:51], v[156:171]
  v_exp_f32 v207, v207
  v_exp_f32 v208, v208
  v_exp_f32 v209, v209
  v_smfmac_f32_32x32x32_bf16 v[108:123], v[248:251], v[196:203], v19
  v_exp_f32 v210, v210
  v_exp_f32 v211, v211
  v_exp_f32 v212, v212
  v_smfmac_f32_16x16x64_bf16 v[148:151], v[24:27], v[196:203], v19
  v_exp_f32 v213, v213
  v_exp_f32 v214, v214
  v_smfmac_f32_32x32x32_bf16 v[124:139], v[244:247], v[204:211], v19
  ds_read_b128 v[228:231], v16 offset:2048
  v_exp_f32 v215, v215
  v_exp_f32 v216, v216
  v_exp_f32 v217, v217
  v_smfmac_f32_16x16x64_bf16 v[152:155], v[24:27], v[204:211], v19
  ds_read_b128 v[232:235], v17 offset:2048
  v_exp_f32 v218, v218
  v_exp_f32 v219, v219
  s_add_u32 s33, s33, 1
  s_cmp_lt_u32 s33, 7
  s_cbranch_scc1 L_loop
  v_mfma_f32_32x32x16_bf16 v[172:187], v[220:223], v[52:55], 4.0
  v_exp_f32 v156, v156
  v_exp_f32 v157, v157
  v_exp_f32 v158, v158
  v_mfma_f32_32x32x16_bf16 v[172:187], v[224:227], v[56:59], v[172:187]
  v_exp_f32 v159, v159
  v_exp_f32 v160, v160
  v_exp_f32 v161, v161
  v_smfmac_f32_32x32x32_bf16 v[124:139], v[248:251], v[212:219], v19
  v_exp_f32 v162, v162
  v_exp_f32 v163, v163
  v_exp_f32 v164, v164
  v_smfmac_f32_16x16x64_bf16 v[152:155], v[24:27], v[212:219], v19
  v_exp_f32 v165, v165
  v_exp_f32 v166, v166
  v_smfmac_f32_32x32x32_bf16 v[76:91], v[236:239], v[156:163], v19
  v_exp_f32 v167, v167
  v_exp_f32 v168, v168
  v_exp_f32 v169, v169
  v_smfmac_f32_16x16x64_bf16 v[140:143], v[24:27], v[156:163], v19
  v_exp_f32 v170, v170
  v_exp_f32 v171, v171
  v_mfma_f32_32x32x16_bf16 v[188:203], v[220:223], v[60:63], 4.0
  ds_read_b64_tr_b16 v[244:245], v18 offset:18432
  v_exp_f32 v172, v172
  v_exp_f32 v173, v173
  v_exp_f32 v174, v174
  v_mfma_f32_32x32x16_bf16 v[188:203], v[224:227], v[64:67], v[188:203]
  ds_read_b64_tr_b16 v[246:247], v18 offset:18688
  v_exp_f32 v175, v175
  v_exp_f32 v176, v176
  v_exp_f32 v177, v177
  v_smfmac_f32_32x32x32_bf16 v[76:91], v[240:243], v[164:171], v19
  ds_read_b64_tr_b16 v[248:249], v18 offset:19456
  v_exp_f32 v178, v178
  v_exp_f32 v179, v179
  v_exp_f32 v180, v180
  v_smfmac_f32_16x16x64_bf16 v[140:143], v[24:27], v[164:171], v19
  ds_read_b64_tr_b16 v[250:251], v18 offset:19712
  v_exp_f32 v181, v181
  v_exp_f32 v182, v182
  v_smfmac_f32_32x32x32_bf16 v[92:107], v[236:239], v[172:179], v19
  v_exp_f32 v183, v183
  v_exp_f32 v184, v184
  v_exp_f32 v185, v185
  v_smfmac_f32_16x16x64_bf16 v[144:147], v[24:27], v[172:179], v19
  v_exp_f32 v186, v186
  v_exp_f32 v187, v187
  v_mfma_f32_32x32x16_bf16 v[204:219], v[220:223], v[68:71], 4.0
  v_exp_f32 v188, v188
  v_exp_f32 v189, v189
  v_exp_f32 v190, v190
  v_mfma_f32_32x32x16_bf16 v[204:219], v[224:227], v[72:75], v[204:219]
  v_exp_f32 v191, v191
  v_exp_f32 v192, v192
  v_exp_f32 v193, v193
  v_smfmac_f32_32x32x32_bf16 v[92:107], v[240:243], v[180:187], v19
  v_exp_f32 v194, v194
  v_exp_f32 v195, v195
  v_exp_f32 v196, v196
  v_smfmac_f32_16x16x64_bf16 v[144:147], v[24:27], v[180:187], v19
  v_exp_f32 v197, v197
  v_exp_f32 v198, v198
  v_smfmac_f32_32x32x32_bf16 v[108:123], v[236:239], v[188:195], v19
  v_exp_f32 v199, v199
  v_exp_f32 v200, v200
  v_exp_f32 v201, v201
  v_smfmac_f32_16x16x64_bf16 v[148:151], v[24:27], v[188:195], v19
  v_exp_f32 v202, v202
  v_exp_f32 v203, v203
  s_waitcnt lgkmcnt(0)
  v_mfma_f32_32x32x16_bf16 v[156:171], v[228:231], v[44:47], 4.0
  v_exp_f32 v204, v204
  v_exp_f32 v205, v205
  v_exp_f32 v206, v206
  v_mfma_f32_32x32x16_bf16 v[156:171], v[232:235], v[48:51], v[156:171]
  v_exp_f32 v207, v207
  v_exp_f32 v208, v208
  v_exp_f32 v209, v209
  v_smfmac_f32_32x32x32_bf16 v[108:123], v[240:243], v[196:203], v19
  v_exp_f32 v210, v210
  v_exp_f32 v211, v211
  v_exp_f32 v212, v212
  v_smfmac_f32_16x16x64_bf16 v[148:151], v[24:27], v[196:203], v19
  v_exp_f32 v213, v213
  v_exp_f32 v214, v214
  v_smfmac_f32_32x32x32_bf16 v[124:139], v[236:239], v[204:211], v19
  ds_read_b128 v[220:223], v16 offset:4096
  v_exp_f32 v215, v215
  v_exp_f32 v216, v216
  v_exp_f32 v217, v217
  v_smfmac_f32_16x16x64_bf16 v[152:155], v[24:27], v[204:211], v19
  ds_read_b128 v[224:227], v17 offset:4096
  v_exp_f32 v218, v218
  v_exp_f32 v219, v219
  v_mfma_f32_32x32x16_bf16 v[172:187], v[228:231], v[52:55], 4.0
  v_exp_f32 v156, v156
  v_exp_f32 v157, v157
  v_exp_f32 v158, v158
  v_mfma_f32_32x32x16_bf16 v[172:187], v[232:235], v[56:59], v[172:187]
  v_exp_f32 v159, v159
  v_exp_f32 v160, v160
  v_exp_f32 v161, v161
  v_smfmac_f32_32x32x32_bf16 v[124:139], v[240:243], v[212:219], v19
  v_exp_f32 v162, v162
  v_exp_f32 v163, v163
  v_exp_f32 v164, v164
  v_smfmac_f32_16x16x64_bf16 v[152:155], v[24:27], v[212:219], v19
  v_exp_f32 v165, v165
  v_exp_f32 v166, v166
  v_smfmac_f32_32x32x32_bf16 v[76:91], v[244:247], v[156:163], v19
  v_exp_f32 v167, v167
  v_exp_f32 v168, v168
  v_exp_f32 v169, v169
  v_smfmac_f32_16x16x64_bf16 v[140:143], v[24:27], v[156:163], v19
  v_exp_f32 v170, v170
  v_exp_f32 v171, v171
  v_mfma_f32_32x32x16_bf16 v[188:203], v[228:231], v[60:63], 4.0
  ds_read_b64_tr_b16 v[236:237], v18 offset:20480
  v_exp_f32 v172, v172
  v_exp_f32 v173, v173
  v_exp_f32 v174, v174
  v_mfma_f32_32x32x16_bf16 v[188:203], v[232:235], v[64:67], v[188:203]
  ds_read_b64_tr_b16 v[238:239], v18 offset:20736
  v_exp_f32 v175, v175
  v_exp_f32 v176, v176
  v_exp_f32 v177, v177
  v_smfmac_f32_32x32x32_bf16 v[76:91], v[248:251], v[164:171], v19
  ds_read_b64_tr_b16 v[240:241], v18 offset:21504
  v_exp_f32 v178, v178
  v_exp_f32 v179, v179
  v_exp_f32 v180, v180
  v_smfmac_f32_16x16x64_bf16 v[140:143], v[24:27], v[164:171], v19
  ds_read_b64_tr_b16 v[242:243], v18 offset:21760
  v_exp_f32 v181, v181
  v_exp_f32 v182, v182
  v_smfmac_f32_32x32x32_bf16 v[92:107], v[244:247], v[172:179], v19
  v_exp_f32 v183, v183
  v_exp_f32 v184, v184
  v_exp_f32 v185, v185
  v_smfmac_f32_16x16x64_bf16 v[144:147], v[24:27], v[172:179], v19
  v_exp_f32 v186, v186
  v_exp_f32 v187, v187
  v_mfma_f32_32x32x16_bf16 v[204:219], v[228:231], v[68:71], 4.0
  v_exp_f32 v188, v188
  v_exp_f32 v189, v189
  v_exp_f32 v190, v190
  v_mfma_f32_32x32x16_bf16 v[204:219], v[232:235], v[72:75], v[204:219]
  v_exp_f32 v191, v191
  v_exp_f32 v192, v192
  v_exp_f32 v193, v193
  v_smfmac_f32_32x32x32_bf16 v[92:107], v[248:251], v[180:187], v19
  v_exp_f32 v194, v194
  v_exp_f32 v195, v195
  v_exp_f32 v196, v196
  v_smfmac_f32_16x16x64_bf16 v[144:147], v[24:27], v[180:187], v19
  v_exp_f32 v197, v197
  v_exp_f32 v198, v198
  v_smfmac_f32_32x32x32_bf16 v[108:123], v[244:247], v[188:195], v19
  v_exp_f32 v199, v199
  v_exp_f32 v200, v200
  v_exp_f32 v201, v201
  v_smfmac_f32_16x16x64_bf16 v[148:151], v[24:27], v[188:195], v19
  v_exp_f32 v202, v202
  v_exp_f32 v203, v203
  s_waitcnt lgkmcnt(0)
  v_mfma_f32_32x32x16_bf16 v[156:171], v[220:223], v[44:47], 4.0
  v_exp_f32 v204, v204
  v_exp_f32 v205, v205
  v_exp_f32 v206, v206
  v_mfma_f32_32x32x16_bf16 v[156:171], v[224:227], v[48:51], v[156:171]
  v_exp_f32 v207, v207
  v_exp_f32 v208, v208
  v_exp_f32 v209, v209
  v_smfmac_f32_32x32x32_bf16 v[108:123], v[248:251], v[196:203], v19
  v_exp_f32 v210, v210
  v_exp_f32 v211, v211
  v_exp_f32 v212, v212
  v_smfmac_f32_16x16x64_bf16 v[148:151], v[24:27], v[196:203], v19
  v_exp_f32 v213, v213
  v_exp_f32 v214, v214
  v_smfmac_f32_32x32x32_bf16 v[124:139], v[244:247], v[204:211], v19
  ds_read_b128 v[228:231], v16 offset:6144
  v_exp_f32 v215, v215
  v_exp_f32 v216, v216
  v_exp_f32 v217, v217
  v_smfmac_f32_16x16x64_bf16 v[152:155], v[24:27], v[204:211], v19
  ds_read_b128 v[232:235], v17 offset:6144
  v_exp_f32 v218, v218
  v_exp_f32 v219, v219
  v_mfma_f32_32x32x16_bf16 v[172:187], v[220:223], v[52:55], 4.0
  v_exp_f32 v156, v156
  v_exp_f32 v157, v157
  v_exp_f32 v158, v158
  v_mfma_f32_32x32x16_bf16 v[172:187], v[224:227], v[56:59], v[172:187]
  v_exp_f32 v159, v159
  v_exp_f32 v160, v160
  v_exp_f32 v161, v161
  v_smfmac_f32_32x32x32_bf16 v[124:139], v[248:251], v[212:219], v19
  v_exp_f32 v162, v162
  v_exp_f32 v163, v163
  v_exp_f32 v164, v164
  v_smfmac_f32_16x16x64_bf16 v[152:155], v[24:27], v[212:219], v19
  v_exp_f32 v165, v165
  v_exp_f32 v166, v166
  v_smfmac_f32_32x32x32_bf16 v[76:91], v[236:239], v[156:163], v19
  v_exp_f32 v167, v167
  v_exp_f32 v168, v168
  v_exp_f32 v169, v169
  v_smfmac_f32_16x16x64_bf16 v[140:143], v[24:27], v[156:163], v19
  v_exp_f32 v170, v170
  v_exp_f32 v171, v171
  v_mfma_f32_32x32x16_bf16 v[188:203], v[220:223], v[60:63], 4.0
  ds_read_b64_tr_b16 v[244:245], v18 offset:22528
  v_exp_f32 v172, v172
  v_exp_f32 v173, v173
  v_exp_f32 v174, v174
  v_mfma_f32_32x32x16_bf16 v[188:203], v[224:227], v[64:67], v[188:203]
  ds_read_b64_tr_b16 v[246:247], v18 offset:22784
  v_exp_f32 v175, v175
  v_exp_f32 v176, v176
  v_exp_f32 v177, v177
  v_smfmac_f32_32x32x32_bf16 v[76:91], v[240:243], v[164:171], v19
  ds_read_b64_tr_b16 v[248:249], v18 offset:23552
  v_exp_f32 v178, v178
  v_exp_f32 v179, v179
  v_exp_f32 v180, v180
  v_smfmac_f32_16x16x64_bf16 v[140:143], v[24:27], v[164:171], v19
  ds_read_b64_tr_b16 v[250:251], v18 offset:23808
  v_exp_f32 v181, v181
  v_exp_f32 v182, v182
  v_smfmac_f32_32x32x32_bf16 v[92:107], v[236:239], v[172:179], v19
  v_exp_f32 v183, v183
  v_exp_f32 v184, v184
  v_exp_f32 v185, v185
  v_smfmac_f32_16x16x64_bf16 v[144:147], v[24:27], v[172:179], v19
  v_exp_f32 v186, v186
  v_exp_f32 v187, v187
  v_mfma_f32_32x32x16_bf16 v[204:219], v[220:223], v[68:71], 4.0
  v_exp_f32 v188, v188
  v_exp_f32 v189, v189
  v_exp_f32 v190, v190
  v_mfma_f32_32x32x16_bf16 v[204:219], v[224:227], v[72:75], v[204:219]
  v_exp_f32 v191, v191
  v_exp_f32 v192, v192
  v_exp_f32 v193, v193
  v_smfmac_f32_32x32x32_bf16 v[92:107], v[240:243], v[180:187], v19
  v_exp_f32 v194, v194
  v_exp_f32 v195, v195
  v_exp_f32 v196, v196
  v_smfmac_f32_16x16x64_bf16 v[144:147], v[24:27], v[180:187], v19
  v_exp_f32 v197, v197
  v_exp_f32 v198, v198
  v_smfmac_f32_32x32x32_bf16 v[108:123], v[236:239], v[188:195], v19
  v_exp_f32 v199, v199
  v_exp_f32 v200, v200
  v_exp_f32 v201, v201
  v_smfmac_f32_16x16x64_bf16 v[148:151], v[24:27], v[188:195], v19
  v_exp_f32 v202, v202
  v_exp_f32 v203, v203
  s_waitcnt lgkmcnt(0)
  v_mfma_f32_32x32x16_bf16 v[156:171], v[228:231], v[44:47], 4.0
  v_exp_f32 v204, v204
  v_exp_f32 v205, v205
  v_exp_f32 v206, v206
  v_mfma_f32_32x32x16_bf16 v[156:171], v[232:235], v[48:51], v[156:171]
  v_exp_f32 v207, v207
  v_exp_f32 v208, v208
  v_exp_f32 v209, v209
  v_smfmac_f32_32x32x32_bf16 v[108:123], v[240:243], v[196:203], v19
  v_exp_f32 v210, v210
  v_exp_f32 v211, v211
  v_exp_f32 v212, v212
  v_smfmac_f32_16x16x64_bf16 v[148:151], v[24:27], v[196:203], v19
  v_exp_f32 v213, v213
  v_exp_f32 v214, v214
  v_smfmac_f32_32x32x32_bf16 v[124:139], v[236:239], v[204:211], v19
  ds_read_b128 v[220:223], v16 offset:8192
  v_exp_f32 v215, v215
  v_exp_f32 v216, v216
  v_exp_f32 v217, v217
  v_smfmac_f32_16x16x64_bf16 v[152:155], v[24:27], v[204:211], v19
  ds_read_b128 v[224:227], v17 offset:8192
  v_exp_f32 v218, v218
  v_exp_f32 v219, v219
  v_mfma_f32_32x32x16_bf16 v[172:187], v[228:231], v[52:55], 4.0
  v_exp_f32 v156, v156
  v_exp_f32 v157, v157
  v_exp_f32 v158, v158
  v_mfma_f32_32x32x16_bf16 v[172:187], v[232:235], v[56:59], v[172:187]
  v_exp_f32 v159, v159
  v_exp_f32 v160, v160
  v_exp_f32 v161, v161
  v_smfmac_f32_32x32x32_bf16 v[124:139], v[240:243], v[212:219], v19
  v_exp_f32 v162, v162
  v_exp_f32 v163, v163
  v_exp_f32 v164, v164
  v_smfmac_f32_16x16x64_bf16 v[152:155], v[24:27], v[212:219], v19
  v_exp_f32 v165, v165
  v_exp_f32 v166, v166
  v_smfmac_f32_32x32x32_bf16 v[76:91], v[244:247], v[156:163], v19
  v_exp_f32 v167, v167
  v_exp_f32 v168, v168
  v_exp_f32 v169, v169
  v_smfmac_f32_16x16x64_bf16 v[140:143], v[24:27], v[156:163], v19
  v_exp_f32 v170, v170
  v_exp_f32 v171, v171
  v_mfma_f32_32x32x16_bf16 v[188:203], v[228:231], v[60:63], 4.0
  ds_read_b64_tr_b16 v[236:237], v18 offset:24576
  v_exp_f32 v172, v172
  v_exp_f32 v173, v173
  v_exp_f32 v174, v174
  v_mfma_f32_32x32x16_bf16 v[188:203], v[232:235], v[64:67], v[188:203]
  ds_read_b64_tr_b16 v[238:239], v18 offset:24832
  v_exp_f32 v175, v175
  v_exp_f32 v176, v176
  v_exp_f32 v177, v177
  v_smfmac_f32_32x32x32_bf16 v[76:91], v[248:251], v[164:171], v19
  ds_read_b64_tr_b16 v[240:241], v18 offset:25600
  v_exp_f32 v178, v178
  v_exp_f32 v179, v179
  v_exp_f32 v180, v180
  v_smfmac_f32_16x16x64_bf16 v[140:143], v[24:27], v[164:171], v19
  ds_read_b64_tr_b16 v[242:243], v18 offset:25856
  v_exp_f32 v181, v181
  v_exp_f32 v182, v182
  v_smfmac_f32_32x32x32_bf16 v[92:107], v[244:247], v[172:179], v19
  v_exp_f32 v183, v183
  v_exp_f32 v184, v184
  v_exp_f32 v185, v185
  v_smfmac_f32_16x16x64_bf16 v[144:147], v[24:27], v[172:179], v19
  v_exp_f32 v186, v186
  v_exp_f32 v187, v187
  v_mfma_f32_32x32x16_bf16 v[204:219], v[228:231], v[68:71], 4.0
  v_exp_f32 v188, v188
  v_exp_f32 v189, v189
  v_exp_f32 v190, v190
  v_mfma_f32_32x32x16_bf16 v[204:219], v[232:235], v[72:75], v[204:219]
  v_exp_f32 v191, v191
  v_exp_f32 v192, v192
  v_exp_f32 v193, v193
  v_smfmac_f32_32x32x32_bf16 v[92:107], v[248:251], v[180:187], v19
  v_exp_f32 v194, v194
  v_exp_f32 v195, v195
  v_exp_f32 v196, v196
  v_smfmac_f32_16x16x64_bf16 v[144:147], v[24:27], v[180:187], v19
  v_exp_f32 v197, v197
  v_exp_f32 v198, v198
  v_smfmac_f32_32x32x32_bf16 v[108:123], v[244:247], v[188:195], v19
  v_exp_f32 v199, v199
  v_exp_f32 v200, v200
  v_exp_f32 v201, v201
  v_smfmac_f32_16x16x64_bf16 v[148:151], v[24:27], v[188:195], v19
  v_exp_f32 v202, v202
  v_exp_f32 v203, v203
  s_waitcnt lgkmcnt(0)
  v_mfma_f32_32x32x16_bf16 v[156:171], v[220:223], v[44:47], 4.0
  v_exp_f32 v204, v204
  v_exp_f32 v205, v205
  v_exp_f32 v206, v206
  v_mfma_f32_32x32x16_bf16 v[156:171], v[224:227], v[48:51], v[156:171]
  v_exp_f32 v207, v207
  v_exp_f32 v208, v208
  v_exp_f32 v209, v209
  v_smfmac_f32_32x32x32_bf16 v[108:123], v[248:251], v[196:203], v19
  v_exp_f32 v210, v210
  v_exp_f32 v211, v211
  v_exp_f32 v212, v212
  v_smfmac_f32_16x16x64_bf16 v[148:151], v[24:27], v[196:203], v19
  v_exp_f32 v213, v213
  v_exp_f32 v214, v214
  v_smfmac_f32_32x32x32_bf16 v[124:139], v[244:247], v[204:211], v19
  ds_read_b128 v[228:231], v16 offset:10240
  v_exp_f32 v215, v215
  v_exp_f32 v216, v216
  v_exp_f32 v217, v217
  v_smfmac_f32_16x16x64_bf16 v[152:155], v[24:27], v[204:211], v19
  ds_read_b128 v[232:235], v17 offset:10240
  v_exp_f32 v218, v218
  v_exp_f32 v219, v219
  v_mfma_f32_32x32x16_bf16 v[172:187], v[220:223], v[52:55], 4.0
  v_exp_f32 v156, v156
  v_exp_f32 v157, v157
  v_exp_f32 v158, v158
  v_mfma_f32_32x32x16_bf16 v[172:187], v[224:227], v[56:59], v[172:187]
  v_exp_f32 v159, v159
  v_exp_f32 v160, v160
  v_exp_f32 v161, v161
  v_smfmac_f32_32x32x32_bf16 v[124:139], v[248:251], v[212:219], v19
  v_exp_f32 v162, v162
  v_exp_f32 v163, v163
  v_exp_f32 v164, v164
  v_smfmac_f32_16x16x64_bf16 v[152:155], v[24:27], v[212:219], v19
  v_exp_f32 v165, v165
  v_exp_f32 v166, v166
  v_smfmac_f32_32x32x32_bf16 v[76:91], v[236:239], v[156:163], v19
  v_exp_f32 v167, v167
  v_exp_f32 v168, v168
  v_exp_f32 v169, v169
  v_smfmac_f32_16x16x64_bf16 v[140:143], v[24:27], v[156:163], v19
  v_exp_f32 v170, v170
  v_exp_f32 v171, v171
  v_mfma_f32_32x32x16_bf16 v[188:203], v[220:223], v[60:63], 4.0
  ds_read_b64_tr_b16 v[244:245], v18 offset:26624
  v_exp_f32 v172, v172
  v_exp_f32 v173, v173
  v_exp_f32 v174, v174
  v_mfma_f32_32x32x16_bf16 v[188:203], v[224:227], v[64:67], v[188:203]
  ds_read_b64_tr_b16 v[246:247], v18 offset:26880
  v_exp_f32 v175, v175
  v_exp_f32 v176, v176
  v_exp_f32 v177, v177
  v_smfmac_f32_32x32x32_bf16 v[76:91], v[240:243], v[164:171], v19
  ds_read_b64_tr_b16 v[248:249], v18 offset:27648
  v_exp_f32 v178, v178
  v_exp_f32 v179, v179
  v_exp_f32 v180, v180
  v_smfmac_f32_16x16x64_bf16 v[140:143], v[24:27], v[164:171], v19
  ds_read_b64_tr_b16 v[250:251], v18 offset:27904
  v_exp_f32 v181, v181
  v_exp_f32 v182, v182
  v_smfmac_f32_32x32x32_bf16 v[92:107], v[236:239], v[172:179], v19
  v_exp_f32 v183, v183
  v_exp_f32 v184, v184
  v_exp_f32 v185, v185
  v_smfmac_f32_16x16x64_bf16 v[144:147], v[24:27], v[172:179], v19
  v_exp_f32 v186, v186
  v_exp_f32 v187, v187
  v_mfma_f32_32x32x16_bf16 v[204:219], v[220:223], v[68:71], 4.0
  v_exp_f32 v188, v188
  v_exp_f32 v189, v189
  v_exp_f32 v190, v190
  v_mfma_f32_32x32x16_bf16 v[204:219], v[224:227], v[72:75], v[204:219]
  v_exp_f32 v191, v191
  v_exp_f32 v192, v192
  v_exp_f32 v193, v193
  v_smfmac_f32_32x32x32_bf16 v[92:107], v[240:243], v[180:187], v19
  v_exp_f32 v194, v194
  v_exp_f32 v195, v195
  v_exp_f32 v196, v196
  v_smfmac_f32_16x16x64_bf16 v[144:147], v[24:27], v[180:187], v19
  v_exp_f32 v197, v197
  v_exp_f32 v198, v198
  v_smfmac_f32_32x32x32_bf16 v[108:123], v[236:239], v[188:195], v19
  v_exp_f32 v199, v199
  v_exp_f32 v200, v200
  v_exp_f32 v201, v201
  v_smfmac_f32_16x16x64_bf16 v[148:151], v[24:27], v[188:195], v19
  v_exp_f32 v202, v202
  v_exp_f32 v203, v203
  s_waitcnt lgkmcnt(0)
  v_mfma_f32_32x32x16_bf16 v[156:171], v[228:231], v[44:47], 4.0
  v_exp_f32 v204, v204
  v_exp_f32 v205, v205
  v_exp_f32 v206, v206
  v_mfma_f32_32x32x16_bf16 v[156:171], v[232:235], v[48:51], v[156:171]
  v_exp_f32 v207, v207
  v_exp_f32 v208, v208
  v_exp_f32 v209, v209
  v_smfmac_f32_32x32x32_bf16 v[108:123], v[240:243], v[196:203], v19
  v_exp_f32 v210, v210
  v_exp_f32 v211, v211
  v_exp_f32 v212, v212
  v_smfmac_f32_16x16x64_bf16 v[148:151], v[24:27], v[196:203], v19
  v_exp_f32 v213, v213
  v_exp_f32 v214, v214
  v_smfmac_f32_32x32x32_bf16 v[124:139], v[236:239], v[204:211], v19
  ds_read_b128 v[220:223], v16 offset:12288
  v_exp_f32 v215, v215
  v_exp_f32 v216, v216
  v_exp_f32 v217, v217
  v_smfmac_f32_16x16x64_bf16 v[152:155], v[24:27], v[204:211], v19
  ds_read_b128 v[224:227], v17 offset:12288
  v_exp_f32 v218, v218
  v_exp_f32 v219, v219
  v_mfma_f32_32x32x16_bf16 v[172:187], v[228:231], v[52:55], 4.0
  v_exp_f32 v156, v156
  v_exp_f32 v157, v157
  v_exp_f32 v158, v158
  v_mfma_f32_32x32x16_bf16 v[172:187], v[232:235], v[56:59], v[172:187]
  v_exp_f32 v159, v159
  v_exp_f32 v160, v160
  v_exp_f32 v161, v161
  v_smfmac_f32_32x32x32_bf16 v[124:139], v[240:243], v[212:219], v19
  v_exp_f32 v162, v162
  v_exp_f32 v163, v163
  v_exp_f32 v164, v164
  v_smfmac_f32_16x16x64_bf16 v[152:155], v[24:27], v[212:219], v19
  v_exp_f32 v165, v165
  v_exp_f32 v166, v166
  v_smfmac_f32_32x32x32_bf16 v[76:91], v[244:247], v[156:163], v19
  v_exp_f32 v167, v167
  v_exp_f32 v168, v168
  v_exp_f32 v169, v169
  v_smfmac_f32_16x16x64_bf16 v[140:143], v[24:27], v[156:163], v19
  v_exp_f32 v170, v170
  v_exp_f32 v171, v171
  v_mfma_f32_32x32x16_bf16 v[188:203], v[228:231], v[60:63], 4.0
  ds_read_b64_tr_b16 v[236:237], v18 offset:28672
  v_exp_f32 v172, v172
  v_exp_f32 v173, v173
  v_exp_f32 v174, v174
  v_mfma_f32_32x32x16_bf16 v[188:203], v[232:235], v[64:67], v[188:203]
  ds_read_b64_tr_b16 v[238:239], v18 offset:28928
  v_exp_f32 v175, v175
  v_exp_f32 v176, v176
  v_exp_f32 v177, v177
  v_smfmac_f32_32x32x32_bf16 v[76:91], v[248:251], v[164:171], v19
  ds_read_b64_tr_b16 v[240:241], v18 offset:29696
  v_exp_f32 v178, v178
  v_exp_f32 v179, v179
  v_exp_f32 v180, v180
  v_smfmac_f32_16x16x64_bf16 v[140:143], v[24:27], v[164:171], v19
  ds_read_b64_tr_b16 v[242:243], v18 offset:29952
  v_exp_f32 v181, v181
  v_exp_f32 v182, v182
  v_smfmac_f32_32x32x32_bf16 v[92:107], v[244:247], v[172:179], v19
  v_exp_f32 v183, v183
  v_exp_f32 v184, v184
  v_exp_f32 v185, v185
  v_smfmac_f32_16x16x64_bf16 v[144:147], v[24:27], v[172:179], v19
  v_exp_f32 v186, v186
  v_exp_f32 v187, v187
  v_mfma_f32_32x32x16_bf16 v[204:219], v[228:231], v[68:71], 4.0
  v_exp_f32 v188, v188
  v_exp_f32 v189, v189
  v_exp_f32 v190, v190
  v_mfma_f32_32x32x16_bf16 v[204:219], v[232:235], v[72:75], v[204:219]
  v_exp_f32 v191, v191
  v_exp_f32 v192, v192
  v_exp_f32 v193, v193
  v_smfmac_f32_32x32x32_bf16 v[92:107], v[248:251], v[180:187], v19
  v_exp_f32 v194, v194
  v_exp_f32 v195, v195
  v_exp_f32 v196, v196
  v_smfmac_f32_16x16x64_bf16 v[144:147], v[24:27], v[180:187], v19
  v_exp_f32 v197, v197
  v_exp_f32 v198, v198
  v_smfmac_f32_32x32x32_bf16 v[108:123], v[244:247], v[188:195], v19
  v_exp_f32 v199, v199
  v_exp_f32 v200, v200
  v_exp_f32 v201, v201
  v_smfmac_f32_16x16x64_bf16 v[148:151], v[24:27], v[188:195], v19
  v_exp_f32 v202, v202
  v_exp_f32 v203, v203
  s_waitcnt lgkmcnt(0)
  v_mfma_f32_32x32x16_bf16 v[156:171], v[220:223], v[44:47], 4.0
  v_exp_f32 v204, v204
  v_exp_f32 v205, v205
  v_exp_f32 v206, v206
  v_mfma_f32_32x32x16_bf16 v[156:171], v[224:227], v[48:51], v[156:171]
  v_exp_f32 v207, v207
  v_exp_f32 v208, v208
  v_exp_f32 v209, v209
  v_smfmac_f32_32x32x32_bf16 v[108:123], v[248:251], v[196:203], v19
  v_exp_f32 v210, v210
  v_exp_f32 v211, v211
  v_exp_f32 v212, v212
  v_smfmac_f32_16x16x64_bf16 v[148:151], v[24:27], v[196:203], v19
  v_exp_f32 v213, v213
  v_exp_f32 v214, v214
  v_smfmac_f32_32x32x32_bf16 v[124:139], v[244:247], v[204:211], v19
  ds_read_b128 v[228:231], v16 offset:14336
  v_exp_f32 v215, v215
  v_exp_f32 v216, v216
  v_exp_f32 v217, v217
  v_smfmac_f32_16x16x64_bf16 v[152:155], v[24:27], v[204:211], v19
  ds_read_b128 v[232:235], v17 offset:14336
  v_exp_f32 v218, v218
  v_exp_f32 v219, v219
  v_mfma_f32_32x32x16_bf16 v[172:187], v[220:223], v[52:55], 4.0
  v_exp_f32 v156, v156
  v_exp_f32 v157, v157
  v_exp_f32 v158, v158
  v_mfma_f32_32x32x16_bf16 v[172:187], v[224:227], v[56:59], v[172:187]
  v_exp_f32 v159, v159
  v_exp_f32 v160, v160
  v_exp_f32 v161, v161
  v_smfmac_f32_32x32x32_bf16 v[124:139], v[248:251], v[212:219], v19
  v_exp_f32 v162, v162
  v_exp_f32 v163, v163
  v_exp_f32 v164, v164
  v_smfmac_f32_16x16x64_bf16 v[152:155], v[24:27], v[212:219], v19
  v_exp_f32 v165, v165
  v_exp_f32 v166, v166
  v_smfmac_f32_32x32x32_bf16 v[76:91], v[236:239], v[156:163], v19
  v_exp_f32 v167, v167
  v_exp_f32 v168, v168
  v_exp_f32 v169, v169
  v_smfmac_f32_16x16x64_bf16 v[140:143], v[24:27], v[156:163], v19
  v_exp_f32 v170, v170
  v_exp_f32 v171, v171
  s_waitcnt lgkmcnt(0)
  v_mfma_f32_32x32x16_bf16 v[188:203], v[228:231], v[44:47], 4.0
  ds_read_b64_tr_b16 v[244:245], v18 offset:30720
  v_exp_f32 v172, v172
  v_exp_f32 v173, v173
  v_exp_f32 v174, v174
  v_mfma_f32_32x32x16_bf16 v[188:203], v[232:235], v[48:51], v[188:203]
  ds_read_b64_tr_b16 v[246:247], v18 offset:30976
  v_exp_f32 v175, v175
  v_exp_f32 v176, v176
  v_exp_f32 v177, v177
  v_smfmac_f32_32x32x32_bf16 v[76:91], v[240:243], v[164:171], v19
  ds_read_b64_tr_b16 v[248:249], v18 offset:31744
  v_exp_f32 v178, v178
  v_exp_f32 v179, v179
  v_exp_f32 v180, v180
  v_smfmac_f32_16x16x64_bf16 v[140:143], v[24:27], v[164:171], v19
  ds_read_b64_tr_b16 v[250:251], v18 offset:32000
  v_exp_f32 v181, v181
  v_exp_f32 v182, v182
  v_smfmac_f32_32x32x32_bf16 v[92:107], v[236:239], v[172:179], v19
  ds_read_b128 v[220:223], v16 offset:12288
  v_exp_f32 v183, v183
  v_exp_f32 v184, v184
  v_exp_f32 v185, v185
  v_smfmac_f32_16x16x64_bf16 v[144:147], v[24:27], v[172:179], v19
  ds_read_b128 v[224:227], v17 offset:12288
  v_exp_f32 v186, v186
  v_exp_f32 v187, v187
  v_mfma_f32_32x32x16_bf16 v[204:219], v[228:231], v[52:55], 4.0
  v_exp_f32 v188, v188
  v_exp_f32 v189, v189
  v_exp_f32 v190, v190
  v_mfma_f32_32x32x16_bf16 v[204:219], v[232:235], v[56:59], v[204:219]
  v_exp_f32 v191, v191
  v_exp_f32 v192, v192
  v_exp_f32 v193, v193
  v_smfmac_f32_32x32x32_bf16 v[92:107], v[240:243], v[180:187], v19
  v_exp_f32 v194, v194
  v_exp_f32 v195, v195
  v_exp_f32 v196, v196
  v_smfmac_f32_16x16x64_bf16 v[144:147], v[24:27], v[180:187], v19
  v_exp_f32 v197, v197
  v_exp_f32 v198, v198
  s_waitcnt lgkmcnt(2)
  v_smfmac_f32_32x32x32_bf16 v[76:91], v[244:247], v[188:195], v19
  v_exp_f32 v199, v199
  v_exp_f32 v200, v200
  v_exp_f32 v201, v201
  v_smfmac_f32_16x16x64_bf16 v[140:143], v[24:27], v[188:195], v19
  v_exp_f32 v202, v202
  v_exp_f32 v203, v203
  s_waitcnt lgkmcnt(0)
  v_mfma_f32_32x32x16_bf16 v[156:171], v[220:223], v[60:63], 4.0
  ds_read_b64_tr_b16 v[236:237], v18 offset:28672
  v_exp_f32 v204, v204
  v_exp_f32 v205, v205
  v_exp_f32 v206, v206
  v_mfma_f32_32x32x16_bf16 v[156:171], v[224:227], v[64:67], v[156:171]
  ds_read_b64_tr_b16 v[238:239], v18 offset:28928
  v_exp_f32 v207, v207
  v_exp_f32 v208, v208
  v_exp_f32 v209, v209
  v_smfmac_f32_32x32x32_bf16 v[76:91], v[248:251], v[196:203], v19
  ds_read_b64_tr_b16 v[240:241], v18 offset:29696
  v_exp_f32 v210, v210
  v_exp_f32 v211, v211
  v_exp_f32 v212, v212
  v_smfmac_f32_16x16x64_bf16 v[140:143], v[24:27], v[196:203], v19
  ds_read_b64_tr_b16 v[242:243], v18 offset:29952
  v_exp_f32 v213, v213
  v_exp_f32 v214, v214
  v_smfmac_f32_32x32x32_bf16 v[92:107], v[244:247], v[204:211], v19
  ds_read_b128 v[228:231], v16 offset:14336
  v_exp_f32 v215, v215
  v_exp_f32 v216, v216
  v_exp_f32 v217, v217
  v_smfmac_f32_16x16x64_bf16 v[144:147], v[24:27], v[204:211], v19
  ds_read_b128 v[232:235], v17 offset:14336
  v_exp_f32 v218, v218
  v_exp_f32 v219, v219
  v_mfma_f32_32x32x16_bf16 v[172:187], v[220:223], v[68:71], 4.0
  v_exp_f32 v156, v156
  v_exp_f32 v157, v157
  v_exp_f32 v158, v158
  v_mfma_f32_32x32x16_bf16 v[172:187], v[224:227], v[72:75], v[172:187]
  v_exp_f32 v159, v159
  v_exp_f32 v160, v160
  v_exp_f32 v161, v161
  v_smfmac_f32_32x32x32_bf16 v[92:107], v[248:251], v[212:219], v19
  v_exp_f32 v162, v162
  v_exp_f32 v163, v163
  v_exp_f32 v164, v164
  v_rcp_f32 v2, v140
  s_nop 0
  v_mov_b32 v3, v2
  v_pk_mul_f32 v[76:77], v[76:77], v[2:3]
  v_smfmac_f32_16x16x64_bf16 v[144:147], v[24:27], v[212:219], v19
  v_exp_f32 v165, v165
  v_pk_mul_f32 v[78:79], v[78:79], v[2:3]
  v_pk_mul_f32 v[80:81], v[80:81], v[2:3]
  v_pk_mul_f32 v[82:83], v[82:83], v[2:3]
  v_pk_mul_f32 v[84:85], v[84:85], v[2:3]
  v_exp_f32 v166, v166
  v_pk_mul_f32 v[86:87], v[86:87], v[2:3]
  v_pk_mul_f32 v[88:89], v[88:89], v[2:3]
  v_pk_mul_f32 v[90:91], v[90:91], v[2:3]
  v_cvt_pk_bf16_f32 v28, v76, v77
  s_waitcnt lgkmcnt(2)
  v_smfmac_f32_32x32x32_bf16 v[108:123], v[236:239], v[156:163], v19
  v_exp_f32 v167, v167
  v_cvt_pk_bf16_f32 v29, v78, v79
  v_cvt_pk_bf16_f32 v30, v80, v81
  v_cvt_pk_bf16_f32 v31, v82, v83
  v_cvt_pk_bf16_f32 v32, v84, v85
  v_exp_f32 v168, v168
  v_cvt_pk_bf16_f32 v33, v86, v87
  v_cvt_pk_bf16_f32 v34, v88, v89
  v_cvt_pk_bf16_f32 v35, v90, v91
  s_nop 1
  v_exp_f32 v169, v169
  v_permlane32_swap_b32 v28, v30
  v_permlane32_swap_b32 v29, v31
  v_permlane32_swap_b32 v32, v34
  v_permlane32_swap_b32 v33, v35
  v_smfmac_f32_16x16x64_bf16 v[148:151], v[24:27], v[156:163], v19
  v_exp_f32 v170, v170
  buffer_store_dwordx4 v[28:31], v10, s[24:27], s30 offen offset:0 nt
  buffer_store_dwordx4 v[32:35], v10, s[24:27], s30 offen offset:32 nt
  v_exp_f32 v171, v171
  s_waitcnt lgkmcnt(0)
  v_mfma_f32_32x32x16_bf16 v[188:203], v[228:231], v[60:63], 4.0
  ds_read_b64_tr_b16 v[244:245], v18 offset:30720
  v_exp_f32 v172, v172
  v_exp_f32 v173, v173
  v_exp_f32 v174, v174
  v_mfma_f32_32x32x16_bf16 v[188:203], v[232:235], v[64:67], v[188:203]
  ds_read_b64_tr_b16 v[246:247], v18 offset:30976
  v_exp_f32 v175, v175
  v_exp_f32 v176, v176
  v_exp_f32 v177, v177
  v_smfmac_f32_32x32x32_bf16 v[108:123], v[240:243], v[164:171], v19
  ds_read_b64_tr_b16 v[248:249], v18 offset:31744
  v_exp_f32 v178, v178
  v_exp_f32 v179, v179
  v_exp_f32 v180, v180
  v_rcp_f32 v4, v144
  s_nop 0
  v_mov_b32 v5, v4
  v_pk_mul_f32 v[92:93], v[92:93], v[4:5]
  v_smfmac_f32_16x16x64_bf16 v[148:151], v[24:27], v[164:171], v19
  ds_read_b64_tr_b16 v[250:251], v18 offset:32000
  v_exp_f32 v181, v181
  v_pk_mul_f32 v[94:95], v[94:95], v[4:5]
  v_pk_mul_f32 v[96:97], v[96:97], v[4:5]
  v_pk_mul_f32 v[98:99], v[98:99], v[4:5]
  v_pk_mul_f32 v[100:101], v[100:101], v[4:5]
  v_exp_f32 v182, v182
  v_pk_mul_f32 v[102:103], v[102:103], v[4:5]
  v_pk_mul_f32 v[104:105], v[104:105], v[4:5]
  v_pk_mul_f32 v[106:107], v[106:107], v[4:5]
  v_cvt_pk_bf16_f32 v36, v92, v93
  v_smfmac_f32_32x32x32_bf16 v[124:139], v[236:239], v[172:179], v19
  v_exp_f32 v183, v183
  v_cvt_pk_bf16_f32 v37, v94, v95
  v_cvt_pk_bf16_f32 v38, v96, v97
  v_cvt_pk_bf16_f32 v39, v98, v99
  v_cvt_pk_bf16_f32 v40, v100, v101
  v_exp_f32 v184, v184
  v_cvt_pk_bf16_f32 v41, v102, v103
  v_cvt_pk_bf16_f32 v42, v104, v105
  v_cvt_pk_bf16_f32 v43, v106, v107
  s_nop 1
  v_exp_f32 v185, v185
  v_permlane32_swap_b32 v36, v38
  v_permlane32_swap_b32 v37, v39
  v_permlane32_swap_b32 v40, v42
  v_permlane32_swap_b32 v41, v43
  v_smfmac_f32_16x16x64_bf16 v[152:155], v[24:27], v[172:179], v19
  v_exp_f32 v186, v186
  buffer_store_dwordx4 v[36:39], v10, s[24:27], s30 offen offset:2048 nt
  buffer_store_dwordx4 v[40:43], v10, s[24:27], s30 offen offset:2080 nt
  v_exp_f32 v187, v187
  v_mfma_f32_32x32x16_bf16 v[204:219], v[228:231], v[68:71], 4.0
  v_exp_f32 v188, v188
  v_exp_f32 v189, v189
  v_exp_f32 v190, v190
  v_mfma_f32_32x32x16_bf16 v[204:219], v[232:235], v[72:75], v[204:219]
  v_exp_f32 v191, v191
  v_exp_f32 v192, v192
  v_exp_f32 v193, v193
  v_smfmac_f32_32x32x32_bf16 v[124:139], v[240:243], v[180:187], v19
  v_exp_f32 v194, v194
  v_exp_f32 v195, v195
  v_exp_f32 v196, v196
  v_smfmac_f32_16x16x64_bf16 v[152:155], v[24:27], v[180:187], v19
  v_exp_f32 v197, v197
  v_exp_f32 v198, v198
  s_waitcnt lgkmcnt(0)
  v_smfmac_f32_32x32x32_bf16 v[108:123], v[244:247], v[188:195], v19
  v_exp_f32 v199, v199
  v_exp_f32 v200, v200
  v_exp_f32 v201, v201
  v_smfmac_f32_16x16x64_bf16 v[148:151], v[24:27], v[188:195], v19
  v_exp_f32 v202, v202
  v_exp_f32 v203, v203
  v_exp_f32 v204, v204
  v_exp_f32 v205, v205
  v_exp_f32 v206, v206
  v_exp_f32 v207, v207
  v_exp_f32 v208, v208
  v_exp_f32 v209, v209
  v_smfmac_f32_32x32x32_bf16 v[108:123], v[248:251], v[196:203], v19
  v_exp_f32 v210, v210
  v_exp_f32 v211, v211
  v_exp_f32 v212, v212
  v_smfmac_f32_16x16x64_bf16 v[148:151], v[24:27], v[196:203], v19
  v_exp_f32 v213, v213
  v_exp_f32 v214, v214
  v_smfmac_f32_32x32x32_bf16 v[124:139], v[244:247], v[204:211], v19
  v_exp_f32 v215, v215
  v_exp_f32 v216, v216
  v_exp_f32 v217, v217
  v_smfmac_f32_16x16x64_bf16 v[152:155], v[24:27], v[204:211], v19
  v_exp_f32 v218, v218
  v_exp_f32 v219, v219
  s_nop 1
  v_smfmac_f32_32x32x32_bf16 v[124:139], v[248:251], v[212:219], v19
  v_smfmac_f32_16x16x64_bf16 v[152:155], v[24:27], v[212:219], v19
  v_rcp_f32 v2, v148
  s_nop 0
  v_mov_b32 v3, v2
  v_pk_mul_f32 v[108:109], v[108:109], v[2:3]
  v_pk_mul_f32 v[110:111], v[110:111], v[2:3]
  v_pk_mul_f32 v[112:113], v[112:113], v[2:3]
  v_pk_mul_f32 v[114:115], v[114:115], v[2:3]
  v_pk_mul_f32 v[116:117], v[116:117], v[2:3]
  v_pk_mul_f32 v[118:119], v[118:119], v[2:3]
  v_pk_mul_f32 v[120:121], v[120:121], v[2:3]
  v_pk_mul_f32 v[122:123], v[122:123], v[2:3]
  v_cvt_pk_bf16_f32 v28, v108, v109
  v_cvt_pk_bf16_f32 v29, v110, v111
  v_cvt_pk_bf16_f32 v30, v112, v113
  v_cvt_pk_bf16_f32 v31, v114, v115
  v_cvt_pk_bf16_f32 v32, v116, v117
  v_cvt_pk_bf16_f32 v33, v118, v119
  v_cvt_pk_bf16_f32 v34, v120, v121
  v_cvt_pk_bf16_f32 v35, v122, v123
  s_nop 1
  v_permlane32_swap_b32 v28, v30
  v_permlane32_swap_b32 v29, v31
  v_permlane32_swap_b32 v32, v34
  v_permlane32_swap_b32 v33, v35
  buffer_store_dwordx4 v[28:31], v10, s[24:27], s37 offen offset:0 nt
  buffer_store_dwordx4 v[32:35], v10, s[24:27], s37 offen offset:32 nt
  v_rcp_f32 v4, v152
  s_nop 0
  v_mov_b32 v5, v4
  v_pk_mul_f32 v[124:125], v[124:125], v[4:5]
  v_pk_mul_f32 v[126:127], v[126:127], v[4:5]
  v_pk_mul_f32 v[128:129], v[128:129], v[4:5]
  v_pk_mul_f32 v[130:131], v[130:131], v[4:5]
  v_pk_mul_f32 v[132:133], v[132:133], v[4:5]
  v_pk_mul_f32 v[134:135], v[134:135], v[4:5]
  v_pk_mul_f32 v[136:137], v[136:137], v[4:5]
  v_pk_mul_f32 v[138:139], v[138:139], v[4:5]
  v_cvt_pk_bf16_f32 v36, v124, v125
  v_cvt_pk_bf16_f32 v37, v126, v127
  v_cvt_pk_bf16_f32 v38, v128, v129
  v_cvt_pk_bf16_f32 v39, v130, v131
  v_cvt_pk_bf16_f32 v40, v132, v133
  v_cvt_pk_bf16_f32 v41, v134, v135
  v_cvt_pk_bf16_f32 v42, v136, v137
  v_cvt_pk_bf16_f32 v43, v138, v139
  s_nop 1
  v_permlane32_swap_b32 v36, v38
  v_permlane32_swap_b32 v37, v39
  v_permlane32_swap_b32 v40, v42
  v_permlane32_swap_b32 v41, v43
  buffer_store_dwordx4 v[36:39], v10, s[24:27], s37 offen offset:2048 nt
  buffer_store_dwordx4 v[40:43], v10, s[24:27], s37 offen offset:2080 nt
  v_cmp_le_f32 s[42:43], 1.0, v140
  v_maximum3_f32 v6, |v140|, |v76|, |v77|
  v_maximum3_f32 v6, v6, |v78|, |v79|
  v_maximum3_f32 v6, v6, |v80|, |v81|
  v_maximum3_f32 v6, v6, |v82|, |v83|
  v_maximum3_f32 v6, v6, |v84|, |v85|
  v_maximum3_f32 v6, v6, |v86|, |v87|
  v_maximum3_f32 v6, v6, |v88|, |v89|
  v_maximum3_f32 v6, v6, |v90|, |v91|
  s_and_b64 s[40:41], s[40:41], s[42:43]
  v_cmp_gt_f32 s[42:43], v7, v6
  s_nop 1
  s_and_b64 s[40:41], s[40:41], s[42:43]
  v_cmp_le_f32 s[42:43], 1.0, v144
  v_maximum3_f32 v6, |v144|, |v92|, |v93|
  v_maximum3_f32 v6, v6, |v94|, |v95|
  v_maximum3_f32 v6, v6, |v96|, |v97|
  v_maximum3_f32 v6, v6, |v98|, |v99|
  v_maximum3_f32 v6, v6, |v100|, |v101|
  v_maximum3_f32 v6, v6, |v102|, |v103|
  v_maximum3_f32 v6, v6, |v104|, |v105|
  v_maximum3_f32 v6, v6, |v106|, |v107|
  s_and_b64 s[40:41], s[40:41], s[42:43]
  v_cmp_gt_f32 s[42:43], v7, v6
  s_nop 1
  s_and_b64 s[40:41], s[40:41], s[42:43]
  v_cmp_le_f32 s[42:43], 1.0, v148
  v_maximum3_f32 v6, |v148|, |v108|, |v109|
  v_maximum3_f32 v6, v6, |v110|, |v111|
  v_maximum3_f32 v6, v6, |v112|, |v113|
  v_maximum3_f32 v6, v6, |v114|, |v115|
  v_maximum3_f32 v6, v6, |v116|, |v117|
  v_maximum3_f32 v6, v6, |v118|, |v119|
  v_maximum3_f32 v6, v6, |v120|, |v121|
  v_maximum3_f32 v6, v6, |v122|, |v123|
  s_and_b64 s[40:41], s[40:41], s[42:43]
  v_cmp_gt_f32 s[42:43], v7, v6
  s_nop 1
  s_and_b64 s[40:41], s[40:41], s[42:43]
  v_cmp_le_f32 s[42:43], 1.0, v152
  v_maximum3_f32 v6, |v152|, |v124|, |v125|
  v_maximum3_f32 v6, v6, |v126|, |v127|
  v_maximum3_f32 v6, v6, |v128|, |v129|
  v_maximum3_f32 v6, v6, |v130|, |v131|
  v_maximum3_f32 v6, v6, |v132|, |v133|
  v_maximum3_f32 v6, v6, |v134|, |v135|
  v_maximum3_f32 v6, v6, |v136|, |v137|
  v_maximum3_f32 v6, v6, |v138|, |v139|
  s_and_b64 s[40:41], s[40:41], s[42:43]
  v_cmp_gt_f32 s[42:43], v7, v6
  s_nop 1
  s_and_b64 s[40:41], s[40:41], s[42:43]
  s_cmp_eq_u64 s[40:41], -1
  s_cbranch_scc0 L_fallback
L_done:
L_end:
  s_endpgm
L_fallback:
  s_mov_b32 s31, s28
  s_mov_b32 s33, 0
  v_mov_b32 v4, 0xff800000
  v_mov_b32 v5, 0xff800000
L_fb1_0:
  buffer_load_dwordx4 v[220:223], v10, s[16:19], s31 offen offset:0
  buffer_load_dwordx4 v[224:227], v10, s[16:19], s31 offen offset:32
  s_waitcnt vmcnt(0)
  v_mfma_f32_32x32x16_bf16 v[156:171], v[220:223], v[44:47], 0
  v_mfma_f32_32x32x16_bf16 v[156:171], v[224:227], v[48:51], v[156:171]
  v_mfma_f32_32x32x16_bf16 v[172:187], v[220:223], v[52:55], 0
  v_mfma_f32_32x32x16_bf16 v[172:187], v[224:227], v[56:59], v[172:187]
  s_nop 15
  s_nop 3
  v_max3_f32 v4, v4, v156, v157
  v_max3_f32 v4, v4, v158, v159
  v_max3_f32 v4, v4, v160, v161
  v_max3_f32 v4, v4, v162, v163
  v_max3_f32 v4, v4, v164, v165
  v_max3_f32 v4, v4, v166, v167
  v_max3_f32 v4, v4, v168, v169
  v_max3_f32 v4, v4, v170, v171
  v_max3_f32 v5, v5, v172, v173
  v_max3_f32 v5, v5, v174, v175
  v_max3_f32 v5, v5, v176, v177
  v_max3_f32 v5, v5, v178, v179
  v_max3_f32 v5, v5, v180, v181
  v_max3_f32 v5, v5, v182, v183
  v_max3_f32 v5, v5, v184, v185
  v_max3_f32 v5, v5, v186, v187
  s_add_u32 s31, s31, 2048
  s_add_u32 s33, s33, 1
  s_cmp_lt_u32 s33, 64
  s_cbranch_scc1 L_fb1_0
  v_mov_b32 v6, v4
  s_nop 1
  v_permlane32_swap_b32 v6, v4
  s_nop 1
  v_max_f32 v4, v4, v6
  v_sub_f32 v188, 0, v4
  v_sub_f32 v189, 0, v4
  v_sub_f32 v190, 0, v4
  v_sub_f32 v191, 0, v4
  v_sub_f32 v192, 0, v4
  v_sub_f32 v193, 0, v4
  v_sub_f32 v194, 0, v4
  v_sub_f32 v195, 0, v4
  v_sub_f32 v196, 0, v4
  v_sub_f32 v197, 0, v4
  v_sub_f32 v198, 0, v4
  v_sub_f32 v199, 0, v4
  v_sub_f32 v200, 0, v4
  v_sub_f32 v201, 0, v4
  v_sub_f32 v202, 0, v4
  v_sub_f32 v203, 0, v4
  v_mov_b32 v6, v5
  s_nop 1
  v_permlane32_swap_b32 v6, v5
  s_nop 1
  v_max_f32 v5, v5, v6
  v_sub_f32 v204, 0, v5
  v_sub_f32 v205, 0, v5
  v_sub_f32 v206, 0, v5
  v_sub_f32 v207, 0, v5
  v_sub_f32 v208, 0, v5
  v_sub_f32 v209, 0, v5
  v_sub_f32 v210, 0, v5
  v_sub_f32 v211, 0, v5
  v_sub_f32 v212, 0, v5
  v_sub_f32 v213, 0, v5
  v_sub_f32 v214, 0, v5
  v_sub_f32 v215, 0, v5
  v_sub_f32 v216, 0, v5
  v_sub_f32 v217, 0, v5
  v_sub_f32 v218, 0, v5
  v_sub_f32 v219, 0, v5
  v_mov_b32 v76, 0
  v_mov_b32 v77, 0
  v_mov_b32 v78, 0
  v_mov_b32 v79, 0
  v_mov_b32 v80, 0
  v_mov_b32 v81, 0
  v_mov_b32 v82, 0
  v_mov_b32 v83, 0
  v_mov_b32 v84, 0
  v_mov_b32 v85, 0
  v_mov_b32 v86, 0
  v_mov_b32 v87, 0
  v_mov_b32 v88, 0
  v_mov_b32 v89, 0
  v_mov_b32 v90, 0
  v_mov_b32 v91, 0
  v_mov_b32 v140, 0
  v_mov_b32 v141, 0
  v_mov_b32 v142, 0
  v_mov_b32 v143, 0
  v_mov_b32 v92, 0
  v_mov_b32 v93, 0
  v_mov_b32 v94, 0
  v_mov_b32 v95, 0
  v_mov_b32 v96, 0
  v_mov_b32 v97, 0
  v_mov_b32 v98, 0
  v_mov_b32 v99, 0
  v_mov_b32 v100, 0
  v_mov_b32 v101, 0
  v_mov_b32 v102, 0
  v_mov_b32 v103, 0
  v_mov_b32 v104, 0
  v_mov_b32 v105, 0
  v_mov_b32 v106, 0
  v_mov_b32 v107, 0
  v_mov_b32 v144, 0
  v_mov_b32 v145, 0
  v_mov_b32 v146, 0
  v_mov_b32 v147, 0
  s_mov_b32 s31, s28
  s_mov_b32 s33, 0
L_fb2_0:
  buffer_load_dwordx4 v[220:223], v10, s[16:19], s31 offen offset:0
  buffer_load_dwordx4 v[224:227], v10, s[16:19], s31 offen offset:32
  buffer_load_ushort v28, v20, s[20:23], s31 offen offset:0
  buffer_load_ushort v29, v20, s[20:23], s31 offen offset:64
  buffer_load_ushort v30, v20, s[20:23], s31 offen offset:128
  buffer_load_ushort v31, v20, s[20:23], s31 offen offset:192
  buffer_load_ushort v32, v20, s[20:23], s31 offen offset:256
  buffer_load_ushort v33, v20, s[20:23], s31 offen offset:320
  buffer_load_ushort v34, v20, s[20:23], s31 offen offset:384
  buffer_load_ushort v35, v20, s[20:23], s31 offen offset:448
  buffer_load_ushort v36, v20, s[20:23], s31 offen offset:1024
  buffer_load_ushort v37, v20, s[20:23], s31 offen offset:1088
  buffer_load_ushort v38, v20, s[20:23], s31 offen offset:1152
  buffer_load_ushort v39, v20, s[20:23], s31 offen offset:1216
  buffer_load_ushort v40, v20, s[20:23], s31 offen offset:1280
  buffer_load_ushort v41, v20, s[20:23], s31 offen offset:1344
  buffer_load_ushort v42, v20, s[20:23], s31 offen offset:1408
  buffer_load_ushort v43, v20, s[20:23], s31 offen offset:1472
  s_waitcnt vmcnt(0)
  v_lshl_or_b32 v236, v29, 16, v28
  v_lshl_or_b32 v237, v31, 16, v30
  v_lshl_or_b32 v238, v33, 16, v32
  v_lshl_or_b32 v239, v35, 16, v34
  v_lshl_or_b32 v240, v37, 16, v36
  v_lshl_or_b32 v241, v39, 16, v38
  v_lshl_or_b32 v242, v41, 16, v40
  v_lshl_or_b32 v243, v43, 16, v42
  v_mfma_f32_32x32x16_bf16 v[156:171], v[220:223], v[44:47], v[188:203]
  v_mfma_f32_32x32x16_bf16 v[156:171], v[224:227], v[48:51], v[156:171]
  v_mfma_f32_32x32x16_bf16 v[172:187], v[220:223], v[52:55], v[204:219]
  v_mfma_f32_32x32x16_bf16 v[172:187], v[224:227], v[56:59], v[172:187]
  s_nop 15
  s_nop 3
  v_exp_f32 v156, v156
  v_exp_f32 v157, v157
  v_exp_f32 v158, v158
  v_exp_f32 v159, v159
  v_exp_f32 v160, v160
  v_exp_f32 v161, v161
  v_exp_f32 v162, v162
  v_exp_f32 v163, v163
  v_exp_f32 v164, v164
  v_exp_f32 v165, v165
  v_exp_f32 v166, v166
  v_exp_f32 v167, v167
  v_exp_f32 v168, v168
  v_exp_f32 v169, v169
  v_exp_f32 v170, v170
  v_exp_f32 v171, v171
  v_exp_f32 v172, v172
  v_exp_f32 v173, v173
  v_exp_f32 v174, v174
  v_exp_f32 v175, v175
  v_exp_f32 v176, v176
  v_exp_f32 v177, v177
  v_exp_f32 v178, v178
  v_exp_f32 v179, v179
  v_exp_f32 v180, v180
  v_exp_f32 v181, v181
  v_exp_f32 v182, v182
  v_exp_f32 v183, v183
  v_exp_f32 v184, v184
  v_exp_f32 v185, v185
  v_exp_f32 v186, v186
  v_exp_f32 v187, v187
  s_nop 3
  v_smfmac_f32_32x32x32_bf16 v[76:91], v[236:239], v[156:163], v19
  v_smfmac_f32_32x32x32_bf16 v[76:91], v[240:243], v[164:171], v19
  v_smfmac_f32_16x16x64_bf16 v[140:143], v[24:27], v[156:163], v19
  v_smfmac_f32_16x16x64_bf16 v[140:143], v[24:27], v[164:171], v19
  v_smfmac_f32_32x32x32_bf16 v[92:107], v[236:239], v[172:179], v19
  v_smfmac_f32_32x32x32_bf16 v[92:107], v[240:243], v[180:187], v19
  v_smfmac_f32_16x16x64_bf16 v[144:147], v[24:27], v[172:179], v19
  v_smfmac_f32_16x16x64_bf16 v[144:147], v[24:27], v[180:187], v19
  s_add_u32 s31, s31, 2048
  s_add_u32 s33, s33, 1
  s_cmp_lt_u32 s33, 64
  s_nop 15
  s_cbranch_scc1 L_fb2_0
  s_nop 15
  v_rcp_f32 v2, v140
  s_nop 0
  v_mov_b32 v3, v2
  v_pk_mul_f32 v[76:77], v[76:77], v[2:3]
  v_pk_mul_f32 v[78:79], v[78:79], v[2:3]
  v_pk_mul_f32 v[80:81], v[80:81], v[2:3]
  v_pk_mul_f32 v[82:83], v[82:83], v[2:3]
  v_pk_mul_f32 v[84:85], v[84:85], v[2:3]
  v_pk_mul_f32 v[86:87], v[86:87], v[2:3]
  v_pk_mul_f32 v[88:89], v[88:89], v[2:3]
  v_pk_mul_f32 v[90:91], v[90:91], v[2:3]
  v_cvt_pk_bf16_f32 v28, v76, v77
  v_cvt_pk_bf16_f32 v29, v78, v79
  v_cvt_pk_bf16_f32 v30, v80, v81
  v_cvt_pk_bf16_f32 v31, v82, v83
  v_cvt_pk_bf16_f32 v32, v84, v85
  v_cvt_pk_bf16_f32 v33, v86, v87
  v_cvt_pk_bf16_f32 v34, v88, v89
  v_cvt_pk_bf16_f32 v35, v90, v91
  s_nop 1
  v_permlane32_swap_b32 v28, v30
  v_permlane32_swap_b32 v29, v31
  v_permlane32_swap_b32 v32, v34
  v_permlane32_swap_b32 v33, v35
  buffer_store_dwordx4 v[28:31], v10, s[24:27], s30 offen offset:0 nt
  buffer_store_dwordx4 v[32:35], v10, s[24:27], s30 offen offset:32 nt
  v_rcp_f32 v4, v144
  s_nop 0
  v_mov_b32 v5, v4
  v_pk_mul_f32 v[92:93], v[92:93], v[4:5]
  v_pk_mul_f32 v[94:95], v[94:95], v[4:5]
  v_pk_mul_f32 v[96:97], v[96:97], v[4:5]
  v_pk_mul_f32 v[98:99], v[98:99], v[4:5]
  v_pk_mul_f32 v[100:101], v[100:101], v[4:5]
  v_pk_mul_f32 v[102:103], v[102:103], v[4:5]
  v_pk_mul_f32 v[104:105], v[104:105], v[4:5]
  v_pk_mul_f32 v[106:107], v[106:107], v[4:5]
  v_cvt_pk_bf16_f32 v36, v92, v93
  v_cvt_pk_bf16_f32 v37, v94, v95
  v_cvt_pk_bf16_f32 v38, v96, v97
  v_cvt_pk_bf16_f32 v39, v98, v99
  v_cvt_pk_bf16_f32 v40, v100, v101
  v_cvt_pk_bf16_f32 v41, v102, v103
  v_cvt_pk_bf16_f32 v42, v104, v105
  v_cvt_pk_bf16_f32 v43, v106, v107
  s_nop 1
  v_permlane32_swap_b32 v36, v38
  v_permlane32_swap_b32 v37, v39
  v_permlane32_swap_b32 v40, v42
  v_permlane32_swap_b32 v41, v43
  buffer_store_dwordx4 v[36:39], v10, s[24:27], s30 offen offset:2048 nt
  buffer_store_dwordx4 v[40:43], v10, s[24:27], s30 offen offset:2080 nt
  s_nop 1
  s_mov_b32 s31, s28
  s_mov_b32 s33, 0
  v_mov_b32 v4, 0xff800000
  v_mov_b32 v5, 0xff800000
L_fb1_1:
  buffer_load_dwordx4 v[220:223], v10, s[16:19], s31 offen offset:0
  buffer_load_dwordx4 v[224:227], v10, s[16:19], s31 offen offset:32
  s_waitcnt vmcnt(0)
  v_mfma_f32_32x32x16_bf16 v[156:171], v[220:223], v[60:63], 0
  v_mfma_f32_32x32x16_bf16 v[156:171], v[224:227], v[64:67], v[156:171]
  v_mfma_f32_32x32x16_bf16 v[172:187], v[220:223], v[68:71], 0
  v_mfma_f32_32x32x16_bf16 v[172:187], v[224:227], v[72:75], v[172:187]
  s_nop 15
  s_nop 3
  v_max3_f32 v4, v4, v156, v157
  v_max3_f32 v4, v4, v158, v159
  v_max3_f32 v4, v4, v160, v161
  v_max3_f32 v4, v4, v162, v163
  v_max3_f32 v4, v4, v164, v165
  v_max3_f32 v4, v4, v166, v167
  v_max3_f32 v4, v4, v168, v169
  v_max3_f32 v4, v4, v170, v171
  v_max3_f32 v5, v5, v172, v173
  v_max3_f32 v5, v5, v174, v175
  v_max3_f32 v5, v5, v176, v177
  v_max3_f32 v5, v5, v178, v179
  v_max3_f32 v5, v5, v180, v181
  v_max3_f32 v5, v5, v182, v183
  v_max3_f32 v5, v5, v184, v185
  v_max3_f32 v5, v5, v186, v187
  s_add_u32 s31, s31, 2048
  s_add_u32 s33, s33, 1
  s_cmp_lt_u32 s33, 64
  s_cbranch_scc1 L_fb1_1
  v_mov_b32 v6, v4
  s_nop 1
  v_permlane32_swap_b32 v6, v4
  s_nop 1
  v_max_f32 v4, v4, v6
  v_sub_f32 v188, 0, v4
  v_sub_f32 v189, 0, v4
  v_sub_f32 v190, 0, v4
  v_sub_f32 v191, 0, v4
  v_sub_f32 v192, 0, v4
  v_sub_f32 v193, 0, v4
  v_sub_f32 v194, 0, v4
  v_sub_f32 v195, 0, v4
  v_sub_f32 v196, 0, v4
  v_sub_f32 v197, 0, v4
  v_sub_f32 v198, 0, v4
  v_sub_f32 v199, 0, v4
  v_sub_f32 v200, 0, v4
  v_sub_f32 v201, 0, v4
  v_sub_f32 v202, 0, v4
  v_sub_f32 v203, 0, v4
  v_mov_b32 v6, v5
  s_nop 1
  v_permlane32_swap_b32 v6, v5
  s_nop 1
  v_max_f32 v5, v5, v6
  v_sub_f32 v204, 0, v5
  v_sub_f32 v205, 0, v5
  v_sub_f32 v206, 0, v5
  v_sub_f32 v207, 0, v5
  v_sub_f32 v208, 0, v5
  v_sub_f32 v209, 0, v5
  v_sub_f32 v210, 0, v5
  v_sub_f32 v211, 0, v5
  v_sub_f32 v212, 0, v5
  v_sub_f32 v213, 0, v5
  v_sub_f32 v214, 0, v5
  v_sub_f32 v215, 0, v5
  v_sub_f32 v216, 0, v5
  v_sub_f32 v217, 0, v5
  v_sub_f32 v218, 0, v5
  v_sub_f32 v219, 0, v5
  v_mov_b32 v108, 0
  v_mov_b32 v109, 0
  v_mov_b32 v110, 0
  v_mov_b32 v111, 0
  v_mov_b32 v112, 0
  v_mov_b32 v113, 0
  v_mov_b32 v114, 0
  v_mov_b32 v115, 0
  v_mov_b32 v116, 0
  v_mov_b32 v117, 0
  v_mov_b32 v118, 0
  v_mov_b32 v119, 0
  v_mov_b32 v120, 0
  v_mov_b32 v121, 0
  v_mov_b32 v122, 0
  v_mov_b32 v123, 0
  v_mov_b32 v148, 0
  v_mov_b32 v149, 0
  v_mov_b32 v150, 0
  v_mov_b32 v151, 0
  v_mov_b32 v124, 0
  v_mov_b32 v125, 0
  v_mov_b32 v126, 0
  v_mov_b32 v127, 0
  v_mov_b32 v128, 0
  v_mov_b32 v129, 0
  v_mov_b32 v130, 0
  v_mov_b32 v131, 0
  v_mov_b32 v132, 0
  v_mov_b32 v133, 0
  v_mov_b32 v134, 0
  v_mov_b32 v135, 0
  v_mov_b32 v136, 0
  v_mov_b32 v137, 0
  v_mov_b32 v138, 0
  v_mov_b32 v139, 0
  v_mov_b32 v152, 0
  v_mov_b32 v153, 0
  v_mov_b32 v154, 0
  v_mov_b32 v155, 0
  s_mov_b32 s31, s28
  s_mov_b32 s33, 0
L_fb2_1:
  buffer_load_dwordx4 v[220:223], v10, s[16:19], s31 offen offset:0
  buffer_load_dwordx4 v[224:227], v10, s[16:19], s31 offen offset:32
  buffer_load_ushort v28, v20, s[20:23], s31 offen offset:0
  buffer_load_ushort v29, v20, s[20:23], s31 offen offset:64
  buffer_load_ushort v30, v20, s[20:23], s31 offen offset:128
  buffer_load_ushort v31, v20, s[20:23], s31 offen offset:192
  buffer_load_ushort v32, v20, s[20:23], s31 offen offset:256
  buffer_load_ushort v33, v20, s[20:23], s31 offen offset:320
  buffer_load_ushort v34, v20, s[20:23], s31 offen offset:384
  buffer_load_ushort v35, v20, s[20:23], s31 offen offset:448
  buffer_load_ushort v36, v20, s[20:23], s31 offen offset:1024
  buffer_load_ushort v37, v20, s[20:23], s31 offen offset:1088
  buffer_load_ushort v38, v20, s[20:23], s31 offen offset:1152
  buffer_load_ushort v39, v20, s[20:23], s31 offen offset:1216
  buffer_load_ushort v40, v20, s[20:23], s31 offen offset:1280
  buffer_load_ushort v41, v20, s[20:23], s31 offen offset:1344
  buffer_load_ushort v42, v20, s[20:23], s31 offen offset:1408
  buffer_load_ushort v43, v20, s[20:23], s31 offen offset:1472
  s_waitcnt vmcnt(0)
  v_lshl_or_b32 v236, v29, 16, v28
  v_lshl_or_b32 v237, v31, 16, v30
  v_lshl_or_b32 v238, v33, 16, v32
  v_lshl_or_b32 v239, v35, 16, v34
  v_lshl_or_b32 v240, v37, 16, v36
  v_lshl_or_b32 v241, v39, 16, v38
  v_lshl_or_b32 v242, v41, 16, v40
  v_lshl_or_b32 v243, v43, 16, v42
  v_mfma_f32_32x32x16_bf16 v[156:171], v[220:223], v[60:63], v[188:203]
  v_mfma_f32_32x32x16_bf16 v[156:171], v[224:227], v[64:67], v[156:171]
  v_mfma_f32_32x32x16_bf16 v[172:187], v[220:223], v[68:71], v[204:219]
  v_mfma_f32_32x32x16_bf16 v[172:187], v[224:227], v[72:75], v[172:187]
  s_nop 15
  s_nop 3
  v_exp_f32 v156, v156
  v_exp_f32 v157, v157
  v_exp_f32 v158, v158
  v_exp_f32 v159, v159
  v_exp_f32 v160, v160
  v_exp_f32 v161, v161
  v_exp_f32 v162, v162
  v_exp_f32 v163, v163
  v_exp_f32 v164, v164
  v_exp_f32 v165, v165
  v_exp_f32 v166, v166
  v_exp_f32 v167, v167
  v_exp_f32 v168, v168
  v_exp_f32 v169, v169
  v_exp_f32 v170, v170
  v_exp_f32 v171, v171
  v_exp_f32 v172, v172
  v_exp_f32 v173, v173
  v_exp_f32 v174, v174
  v_exp_f32 v175, v175
  v_exp_f32 v176, v176
  v_exp_f32 v177, v177
  v_exp_f32 v178, v178
  v_exp_f32 v179, v179
  v_exp_f32 v180, v180
  v_exp_f32 v181, v181
  v_exp_f32 v182, v182
  v_exp_f32 v183, v183
  v_exp_f32 v184, v184
  v_exp_f32 v185, v185
  v_exp_f32 v186, v186
  v_exp_f32 v187, v187
  s_nop 3
  v_smfmac_f32_32x32x32_bf16 v[108:123], v[236:239], v[156:163], v19
  v_smfmac_f32_32x32x32_bf16 v[108:123], v[240:243], v[164:171], v19
  v_smfmac_f32_16x16x64_bf16 v[148:151], v[24:27], v[156:163], v19
  v_smfmac_f32_16x16x64_bf16 v[148:151], v[24:27], v[164:171], v19
  v_smfmac_f32_32x32x32_bf16 v[124:139], v[236:239], v[172:179], v19
  v_smfmac_f32_32x32x32_bf16 v[124:139], v[240:243], v[180:187], v19
  v_smfmac_f32_16x16x64_bf16 v[152:155], v[24:27], v[172:179], v19
  v_smfmac_f32_16x16x64_bf16 v[152:155], v[24:27], v[180:187], v19
  s_add_u32 s31, s31, 2048
  s_add_u32 s33, s33, 1
  s_cmp_lt_u32 s33, 64
  s_nop 15
  s_cbranch_scc1 L_fb2_1
  s_nop 15
  v_rcp_f32 v2, v148
  s_nop 0
  v_mov_b32 v3, v2
  v_pk_mul_f32 v[108:109], v[108:109], v[2:3]
  v_pk_mul_f32 v[110:111], v[110:111], v[2:3]
  v_pk_mul_f32 v[112:113], v[112:113], v[2:3]
  v_pk_mul_f32 v[114:115], v[114:115], v[2:3]
  v_pk_mul_f32 v[116:117], v[116:117], v[2:3]
  v_pk_mul_f32 v[118:119], v[118:119], v[2:3]
  v_pk_mul_f32 v[120:121], v[120:121], v[2:3]
  v_pk_mul_f32 v[122:123], v[122:123], v[2:3]
  v_cvt_pk_bf16_f32 v28, v108, v109
  v_cvt_pk_bf16_f32 v29, v110, v111
  v_cvt_pk_bf16_f32 v30, v112, v113
  v_cvt_pk_bf16_f32 v31, v114, v115
  v_cvt_pk_bf16_f32 v32, v116, v117
  v_cvt_pk_bf16_f32 v33, v118, v119
  v_cvt_pk_bf16_f32 v34, v120, v121
  v_cvt_pk_bf16_f32 v35, v122, v123
  s_nop 1
  v_permlane32_swap_b32 v28, v30
  v_permlane32_swap_b32 v29, v31
  v_permlane32_swap_b32 v32, v34
  v_permlane32_swap_b32 v33, v35
  buffer_store_dwordx4 v[28:31], v10, s[24:27], s37 offen offset:0 nt
  buffer_store_dwordx4 v[32:35], v10, s[24:27], s37 offen offset:32 nt
  v_rcp_f32 v4, v152
  s_nop 0
  v_mov_b32 v5, v4
  v_pk_mul_f32 v[124:125], v[124:125], v[4:5]
  v_pk_mul_f32 v[126:127], v[126:127], v[4:5]
  v_pk_mul_f32 v[128:129], v[128:129], v[4:5]
  v_pk_mul_f32 v[130:131], v[130:131], v[4:5]
  v_pk_mul_f32 v[132:133], v[132:133], v[4:5]
  v_pk_mul_f32 v[134:135], v[134:135], v[4:5]
  v_pk_mul_f32 v[136:137], v[136:137], v[4:5]
  v_pk_mul_f32 v[138:139], v[138:139], v[4:5]
  v_cvt_pk_bf16_f32 v36, v124, v125
  v_cvt_pk_bf16_f32 v37, v126, v127
  v_cvt_pk_bf16_f32 v38, v128, v129
  v_cvt_pk_bf16_f32 v39, v130, v131
  v_cvt_pk_bf16_f32 v40, v132, v133
  v_cvt_pk_bf16_f32 v41, v134, v135
  v_cvt_pk_bf16_f32 v42, v136, v137
  v_cvt_pk_bf16_f32 v43, v138, v139
  s_nop 1
  v_permlane32_swap_b32 v36, v38
  v_permlane32_swap_b32 v37, v39
  v_permlane32_swap_b32 v40, v42
  v_permlane32_swap_b32 v41, v43
  buffer_store_dwordx4 v[36:39], v10, s[24:27], s37 offen offset:2048 nt
  buffer_store_dwordx4 v[40:43], v10, s[24:27], s37 offen offset:2080 nt
  s_nop 1
  s_branch L_done
.section .rodata,"a"
.p2align 6
.amdhsa_kernel standalone__fused_io_aware_attn__prompt_kernel
  .amdhsa_next_free_vgpr 252
  .amdhsa_next_free_sgpr 64
  .amdhsa_accum_offset 252
  .amdhsa_group_segment_fixed_size 0
  .amdhsa_kernarg_size 48
  .amdhsa_user_sgpr_count 2
  .amdhsa_user_sgpr_kernarg_segment_ptr 1
  .amdhsa_system_sgpr_workgroup_id_x 1
.end_amdhsa_kernel
```
